```python
import torch

def _softmax(x, axis=-1):
    return torch.softmax(x, dim=axis)
def _gelu(x):
    return torch.nn.functional.gelu(x, approximate="tanh")
def _silu(x):
    return torch.nn.functional.silu(x)
def _sigmoid(x):
    return torch.sigmoid(x)
def _layernorm(x, axis=-1, eps=1e-5):
    m = x.mean(dim=axis, keepdim=True)
    v = x.var(dim=axis, keepdim=True, unbiased=False)
    return (x - m) / torch.sqrt(v + eps)
def _scatter_add(tgt, idx, src, axis=0):
    return tgt.clone().index_add_(axis, idx, src)
def _segment_sum(src, seg, n):
    out = torch.zeros((n,) + src.shape[1:], dtype=src.dtype)
    return out.index_add_(0, seg, src)
def _pad(x, pw):
    flat = tuple(v for pair in reversed(pw) for v in pair)
    return torch.nn.functional.pad(x, flat)

kernel_name = 'sequential_preLN__spectral_gfnet__geglu_ffn__prompt'

def setup_inputs():

    _w = (lambda a: (lambda t: t.to(torch.bfloat16) if t.is_floating_point() else t)(torch.as_tensor(a)))
    def _A_setup():
        B, S, D = 1, 2048, 512
        Df = D // 2 + 1
        return {
            "x": _w((lambda *s: torch.randn(*s, dtype=torch.bfloat16) * 0.05)(B, S, D)),
            "w_r": _w((lambda *s: torch.randn(*s, dtype=torch.bfloat16) * 0.4)(S, Df) * 0.02),
            "w_i": _w((lambda *s: torch.randn(*s, dtype=torch.bfloat16) * 0.4)(S, Df) * 0.02),
        }
    _A_in = _A_setup()

    def _B_setup():
        B, S, D, F = 1, 2048, 512, 1376
        return {
            "x": _w((lambda *s: torch.randn(*s, dtype=torch.bfloat16) * 0.05)(B, S, D)),
            "w_gate": _w((lambda *s: torch.randn(*s, dtype=torch.bfloat16) * 0.05)(D, F)),
            "w_up": _w((lambda *s: torch.randn(*s, dtype=torch.bfloat16) * 0.05)(D, F)),
            "w_down": _w((lambda *s: torch.randn(*s, dtype=torch.bfloat16) * 0.05)(F, D)),
        }
    _B_in = _B_setup()

    return {
        "A_x": _A_in["x"],
        "A_w_r": _A_in["w_r"],
        "A_w_i": _A_in["w_i"],
        "B_x": _B_in["x"],
        "B_w_gate": _B_in["w_gate"],
        "B_w_up": _B_in["w_up"],
        "B_w_down": _B_in["w_down"],
    }

def reference(A_x, A_w_r, A_w_i, B_x, B_w_gate, B_w_up, B_w_down):
    def _A_ref(x, w_r, w_i):
        B, S, D = x.shape
        X = (lambda x, axes=(-2,-1): torch.fft.rfft2(x.float(), dim=axes))(x, axes=(-2, -1))
        W = w_r + 1j * w_i
        X = X * W
        y = (lambda x, s, axes=(-2,-1): torch.fft.irfft2(x, s=s, dim=axes).to(torch.bfloat16))(X, (S, D), axes=(-2, -1))
        return y

    def _B_ref(x, w_gate, w_up, w_down):
        return (_gelu(x @ w_gate) * (x @ w_up)) @ w_down

    x = A_x
    h = x + _A_ref(_layernorm(x, axis=-1), A_w_r, A_w_i)
    h2 = h + _B_ref(_layernorm(h, axis=-1), B_w_gate, B_w_up, B_w_down)
    return h2
```

```asm
; @launch kernel=k1_kernel grid=(470,1,1) block=(256,1,1) lds=45056
; @launch kernel=k2_kernel grid=(257,1,1) block=(256,1,1) lds=18432
; @launch kernel=k3_kernel grid=(256,1,1) block=(256,1,1) lds=18432
; @launch kernel=k4_kernel grid=(240,1,1) block=(256,1,1) lds=81920
; @launch kernel=k5_kernel grid=(256,1,1) block=(128,1,1) lds=0
.amdgcn_target "amdgcn-amd-amdhsa--gfx950"
.text
.globl k1_kernel
.p2align 8
.type k1_kernel,@function
k1_kernel:
    s_load_dwordx4 s[4:7], s[0:1], 0
    s_load_dwordx2 s[8:9], s[0:1], 16
    s_load_dwordx4 s[12:15], s[0:1], 32
    s_load_dwordx2 s[16:17], s[0:1], 48
    s_load_dwordx2 s[10:11], s[0:1], 72
    s_mov_b32 s20, 0x3f3504f3
    s_mov_b32 s21, 0x3f3504f3
    s_cmp_ge_u32 s2, 470
    s_cbranch_scc1 k1_kernel_end
    s_waitcnt lgkmcnt(0)
    s_mov_b32 s24, s10
    s_and_b32 s25, s11, 0xffff
    s_mov_b32 s26, 20971520
    s_mov_b32 s27, 0x00020000
    s_cmp_ge_u32 s2, 256
    s_cbranch_scc1 k1_kernel_side
    s_mov_b32 s28, s4
    s_and_b32 s29, s5, 0xffff
    s_mov_b32 s30, 2097152
    s_mov_b32 s31, 0x00020000
    v_and_b32 v1, 63, v0
    v_lshrrev_b32 v3, 6, v0
    v_mul_u32_u24 v2, 4608, v3
    s_lshl_b32 s3, s2, 13
    v_lshlrev_b32 v26, 11, v3
    v_lshl_add_u32 v26, v1, 4, v26
    v_add_u32 v26, s3, v26
    buffer_load_dwordx4 v[32:35], v26, s[28:31], 0 offen
    buffer_load_dwordx4 v[36:39], v26, s[28:31], 0 offen offset:1024
    v_xor_b32 v4, 1, v1
    v_lshlrev_b32 v4, 2, v4
    v_xor_b32 v5, 2, v1
    v_lshlrev_b32 v5, 2, v5
    v_xor_b32 v6, 4, v1
    v_lshlrev_b32 v6, 2, v6
    v_xor_b32 v7, 8, v1
    v_lshlrev_b32 v7, 2, v7
    v_xor_b32 v8, 16, v1
    v_lshlrev_b32 v8, 2, v8
    v_xor_b32 v9, 32, v1
    v_lshlrev_b32 v9, 2, v9
    v_lshlrev_b32 v20, 3, v1
    v_add_u32 v20, v20, v2
    v_lshrrev_b32 v10, 3, v1
    v_mul_u32_u24 v10, 576, v10
    v_add_u32 v10, v10, v2
    v_and_b32 v11, 7, v1
    v_lshlrev_b32 v12, 3, v11
    v_add_u32 v21, v10, v12
    v_mov_b32 v22, v21
    v_mul_u32_u24 v12, 72, v11
    v_add_u32 v23, v10, v12
    v_cvt_f32_u32 v24, v1
    v_mul_f32 v24, 0x3b000000, v24
    v_cvt_f32_u32 v25, v11
    v_mul_f32 v25, 0x3c800000, v25
    s_waitcnt vmcnt(0)
    v_lshlrev_b32 v40, 16, v32
    v_and_b32 v41, 0xffff0000, v32
    v_lshlrev_b32 v48, 16, v36
    v_and_b32 v49, 0xffff0000, v36
    v_lshlrev_b32 v42, 16, v33
    v_and_b32 v43, 0xffff0000, v33
    v_lshlrev_b32 v50, 16, v37
    v_and_b32 v51, 0xffff0000, v37
    v_lshlrev_b32 v44, 16, v34
    v_and_b32 v45, 0xffff0000, v34
    v_lshlrev_b32 v52, 16, v38
    v_and_b32 v53, 0xffff0000, v38
    v_lshlrev_b32 v46, 16, v35
    v_and_b32 v47, 0xffff0000, v35
    v_lshlrev_b32 v54, 16, v39
    v_and_b32 v55, 0xffff0000, v39
    v_add_f32 v14, v40, v41
    v_add_f32 v14, v14, v42
    v_add_f32 v14, v14, v43
    v_add_f32 v14, v14, v44
    v_add_f32 v14, v14, v45
    v_add_f32 v14, v14, v46
    v_add_f32 v14, v14, v47
    v_add_f32 v15, v48, v49
    v_add_f32 v15, v15, v50
    v_add_f32 v15, v15, v51
    v_add_f32 v15, v15, v52
    v_add_f32 v15, v15, v53
    v_add_f32 v15, v15, v54
    v_add_f32 v15, v15, v55
    ds_bpermute_b32 v10, v4, v14
    ds_bpermute_b32 v11, v4, v15
    s_waitcnt lgkmcnt(0)
    v_add_f32 v14, v14, v10
    v_add_f32 v15, v15, v11
    ds_bpermute_b32 v10, v5, v14
    ds_bpermute_b32 v11, v5, v15
    s_waitcnt lgkmcnt(0)
    v_add_f32 v14, v14, v10
    v_add_f32 v15, v15, v11
    ds_bpermute_b32 v10, v6, v14
    ds_bpermute_b32 v11, v6, v15
    s_waitcnt lgkmcnt(0)
    v_add_f32 v14, v14, v10
    v_add_f32 v15, v15, v11
    ds_bpermute_b32 v10, v7, v14
    ds_bpermute_b32 v11, v7, v15
    s_waitcnt lgkmcnt(0)
    v_add_f32 v14, v14, v10
    v_add_f32 v15, v15, v11
    ds_bpermute_b32 v10, v8, v14
    ds_bpermute_b32 v11, v8, v15
    s_waitcnt lgkmcnt(0)
    v_add_f32 v14, v14, v10
    v_add_f32 v15, v15, v11
    ds_bpermute_b32 v10, v9, v14
    ds_bpermute_b32 v11, v9, v15
    s_waitcnt lgkmcnt(0)
    v_add_f32 v14, v14, v10
    v_add_f32 v15, v15, v11
    v_mul_f32 v14, 0x3b000000, v14
    v_mul_f32 v15, 0x3b000000, v15
    v_sub_f32 v10, v40, v14
    v_mul_f32 v16, v10, v10
    v_sub_f32 v10, v41, v14
    v_fmac_f32 v16, v10, v10
    v_sub_f32 v10, v42, v14
    v_fmac_f32 v16, v10, v10
    v_sub_f32 v10, v43, v14
    v_fmac_f32 v16, v10, v10
    v_sub_f32 v10, v44, v14
    v_fmac_f32 v16, v10, v10
    v_sub_f32 v10, v45, v14
    v_fmac_f32 v16, v10, v10
    v_sub_f32 v10, v46, v14
    v_fmac_f32 v16, v10, v10
    v_sub_f32 v10, v47, v14
    v_fmac_f32 v16, v10, v10
    v_sub_f32 v10, v48, v15
    v_mul_f32 v17, v10, v10
    v_sub_f32 v10, v49, v15
    v_fmac_f32 v17, v10, v10
    v_sub_f32 v10, v50, v15
    v_fmac_f32 v17, v10, v10
    v_sub_f32 v10, v51, v15
    v_fmac_f32 v17, v10, v10
    v_sub_f32 v10, v52, v15
    v_fmac_f32 v17, v10, v10
    v_sub_f32 v10, v53, v15
    v_fmac_f32 v17, v10, v10
    v_sub_f32 v10, v54, v15
    v_fmac_f32 v17, v10, v10
    v_sub_f32 v10, v55, v15
    v_fmac_f32 v17, v10, v10
    ds_bpermute_b32 v10, v4, v16
    ds_bpermute_b32 v11, v4, v17
    s_waitcnt lgkmcnt(0)
    v_add_f32 v16, v16, v10
    v_add_f32 v17, v17, v11
    ds_bpermute_b32 v10, v5, v16
    ds_bpermute_b32 v11, v5, v17
    s_waitcnt lgkmcnt(0)
    v_add_f32 v16, v16, v10
    v_add_f32 v17, v17, v11
    ds_bpermute_b32 v10, v6, v16
    ds_bpermute_b32 v11, v6, v17
    s_waitcnt lgkmcnt(0)
    v_add_f32 v16, v16, v10
    v_add_f32 v17, v17, v11
    ds_bpermute_b32 v10, v7, v16
    ds_bpermute_b32 v11, v7, v17
    s_waitcnt lgkmcnt(0)
    v_add_f32 v16, v16, v10
    v_add_f32 v17, v17, v11
    ds_bpermute_b32 v10, v8, v16
    ds_bpermute_b32 v11, v8, v17
    s_waitcnt lgkmcnt(0)
    v_add_f32 v16, v16, v10
    v_add_f32 v17, v17, v11
    ds_bpermute_b32 v10, v9, v16
    ds_bpermute_b32 v11, v9, v17
    s_waitcnt lgkmcnt(0)
    v_add_f32 v16, v16, v10
    v_add_f32 v17, v17, v11
    v_mul_f32 v16, 0x3b000000, v16
    v_cvt_pk_bf16_f32 v10, v14, v16
    v_lshlrev_b32 v14, 16, v10
    v_and_b32 v16, 0xffff0000, v10
    v_add_f32 v16, 0x3727c5ac, v16
    v_cvt_pk_bf16_f32 v10, v16, v16
    v_lshlrev_b32 v16, 16, v10
    v_sqrt_f32 v16, v16
    s_nop 0
    v_cvt_pk_bf16_f32 v10, v16, v16
    v_lshlrev_b32 v16, 16, v10
    v_rcp_f32 v16, v16
    s_nop 0
    v_mul_f32 v17, 0x3b000000, v17
    v_cvt_pk_bf16_f32 v10, v15, v17
    v_lshlrev_b32 v15, 16, v10
    v_and_b32 v17, 0xffff0000, v10
    v_add_f32 v17, 0x3727c5ac, v17
    v_cvt_pk_bf16_f32 v10, v17, v17
    v_lshlrev_b32 v17, 16, v10
    v_sqrt_f32 v17, v17
    s_nop 0
    v_cvt_pk_bf16_f32 v10, v17, v17
    v_lshlrev_b32 v17, 16, v10
    v_rcp_f32 v17, v17
    s_nop 0
    v_sub_f32 v40, v40, v14
    v_sub_f32 v41, v41, v14
    v_cvt_pk_bf16_f32 v10, v40, v41
    v_lshlrev_b32 v40, 16, v10
    v_and_b32 v41, 0xffff0000, v10
    v_mul_f32 v40, v40, v16
    v_mul_f32 v41, v41, v16
    v_cvt_pk_bf16_f32 v10, v40, v41
    v_lshlrev_b32 v40, 16, v10
    v_and_b32 v41, 0xffff0000, v10
    v_sub_f32 v42, v42, v14
    v_sub_f32 v43, v43, v14
    v_cvt_pk_bf16_f32 v10, v42, v43
    v_lshlrev_b32 v42, 16, v10
    v_and_b32 v43, 0xffff0000, v10
    v_mul_f32 v42, v42, v16
    v_mul_f32 v43, v43, v16
    v_cvt_pk_bf16_f32 v10, v42, v43
    v_lshlrev_b32 v42, 16, v10
    v_and_b32 v43, 0xffff0000, v10
    v_sub_f32 v44, v44, v14
    v_sub_f32 v45, v45, v14
    v_cvt_pk_bf16_f32 v10, v44, v45
    v_lshlrev_b32 v44, 16, v10
    v_and_b32 v45, 0xffff0000, v10
    v_mul_f32 v44, v44, v16
    v_mul_f32 v45, v45, v16
    v_cvt_pk_bf16_f32 v10, v44, v45
    v_lshlrev_b32 v44, 16, v10
    v_and_b32 v45, 0xffff0000, v10
    v_sub_f32 v46, v46, v14
    v_sub_f32 v47, v47, v14
    v_cvt_pk_bf16_f32 v10, v46, v47
    v_lshlrev_b32 v46, 16, v10
    v_and_b32 v47, 0xffff0000, v10
    v_mul_f32 v46, v46, v16
    v_mul_f32 v47, v47, v16
    v_cvt_pk_bf16_f32 v10, v46, v47
    v_lshlrev_b32 v46, 16, v10
    v_and_b32 v47, 0xffff0000, v10
    v_sub_f32 v48, v48, v15
    v_sub_f32 v49, v49, v15
    v_cvt_pk_bf16_f32 v10, v48, v49
    v_lshlrev_b32 v48, 16, v10
    v_and_b32 v49, 0xffff0000, v10
    v_mul_f32 v48, v48, v17
    v_mul_f32 v49, v49, v17
    v_cvt_pk_bf16_f32 v10, v48, v49
    v_lshlrev_b32 v48, 16, v10
    v_and_b32 v49, 0xffff0000, v10
    v_sub_f32 v50, v50, v15
    v_sub_f32 v51, v51, v15
    v_cvt_pk_bf16_f32 v10, v50, v51
    v_lshlrev_b32 v50, 16, v10
    v_and_b32 v51, 0xffff0000, v10
    v_mul_f32 v50, v50, v17
    v_mul_f32 v51, v51, v17
    v_cvt_pk_bf16_f32 v10, v50, v51
    v_lshlrev_b32 v50, 16, v10
    v_and_b32 v51, 0xffff0000, v10
    v_sub_f32 v52, v52, v15
    v_sub_f32 v53, v53, v15
    v_cvt_pk_bf16_f32 v10, v52, v53
    v_lshlrev_b32 v52, 16, v10
    v_and_b32 v53, 0xffff0000, v10
    v_mul_f32 v52, v52, v17
    v_mul_f32 v53, v53, v17
    v_cvt_pk_bf16_f32 v10, v52, v53
    v_lshlrev_b32 v52, 16, v10
    v_and_b32 v53, 0xffff0000, v10
    v_sub_f32 v54, v54, v15
    v_sub_f32 v55, v55, v15
    v_cvt_pk_bf16_f32 v10, v54, v55
    v_lshlrev_b32 v54, 16, v10
    v_and_b32 v55, 0xffff0000, v10
    v_mul_f32 v54, v54, v17
    v_mul_f32 v55, v55, v17
    v_cvt_pk_bf16_f32 v10, v54, v55
    v_lshlrev_b32 v54, 16, v10
    v_and_b32 v55, 0xffff0000, v10
    v_lshlrev_b32 v27, 6, v1
    v_add_u32 v27, v27, v2
    v_mov_b32 v28, v40
    v_mov_b32 v29, v48
    v_mov_b32 v30, v41
    v_mov_b32 v31, v49
    ds_write_b128 v27, v[28:31] offset:0
    v_mov_b32 v28, v42
    v_mov_b32 v29, v50
    v_mov_b32 v30, v43
    v_mov_b32 v31, v51
    ds_write_b128 v27, v[28:31] offset:16
    v_mov_b32 v28, v44
    v_mov_b32 v29, v52
    v_mov_b32 v30, v45
    v_mov_b32 v31, v53
    ds_write_b128 v27, v[28:31] offset:32
    v_mov_b32 v28, v46
    v_mov_b32 v29, v54
    v_mov_b32 v30, v47
    v_mov_b32 v31, v55
    ds_write_b128 v27, v[28:31] offset:48
    s_waitcnt lgkmcnt(0)
    ds_read_b64 v[32:33], v20 offset:0
    ds_read_b64 v[34:35], v20 offset:512
    ds_read_b64 v[36:37], v20 offset:1024
    ds_read_b64 v[38:39], v20 offset:1536
    ds_read_b64 v[40:41], v20 offset:2048
    ds_read_b64 v[42:43], v20 offset:2560
    ds_read_b64 v[44:45], v20 offset:3072
    ds_read_b64 v[46:47], v20 offset:3584
    s_waitcnt lgkmcnt(0)
    v_pk_add_f32 v[48:49], v[32:33], v[40:41]
    v_pk_add_f32 v[50:51], v[34:35], v[42:43]
    v_pk_add_f32 v[52:53], v[36:37], v[44:45]
    v_pk_add_f32 v[54:55], v[38:39], v[46:47]
    v_pk_add_f32 v[56:57], v[32:33], v[40:41] neg_lo:[0,1] neg_hi:[0,1]
    v_pk_add_f32 v[58:59], v[34:35], v[42:43] neg_lo:[0,1] neg_hi:[0,1]
    v_pk_add_f32 v[60:61], v[36:37], v[44:45] neg_lo:[0,1] neg_hi:[0,1]
    v_pk_add_f32 v[62:63], v[38:39], v[46:47] neg_lo:[0,1] neg_hi:[0,1]
    v_pk_add_f32 v[32:33], v[58:59], v[58:59] op_sel:[0,1] op_sel_hi:[1,0] neg_hi:[0,1]
    v_pk_mul_f32 v[32:33], v[32:33], s[20:21]
    v_pk_add_f32 v[34:35], v[62:63], v[62:63] op_sel:[1,0] op_sel_hi:[0,1] neg_lo:[0,1] neg_hi:[1,1]
    v_pk_mul_f32 v[34:35], v[34:35], s[20:21]
    v_pk_add_f32 v[36:37], v[48:49], v[52:53]
    v_pk_add_f32 v[38:39], v[50:51], v[54:55]
    v_pk_add_f32 v[40:41], v[48:49], v[52:53] neg_lo:[0,1] neg_hi:[0,1]
    v_pk_add_f32 v[42:43], v[50:51], v[54:55] neg_lo:[0,1] neg_hi:[0,1]
    v_pk_add_f32 v[44:45], v[36:37], v[38:39]
    v_pk_add_f32 v[46:47], v[36:37], v[38:39] neg_lo:[0,1] neg_hi:[0,1]
    v_pk_add_f32 v[48:49], v[40:41], v[42:43] op_sel:[0,1] op_sel_hi:[1,0] neg_hi:[0,1]
    v_pk_add_f32 v[50:51], v[40:41], v[42:43] op_sel:[0,1] op_sel_hi:[1,0] neg_lo:[0,1]
    v_pk_add_f32 v[36:37], v[56:57], v[60:61] op_sel:[0,1] op_sel_hi:[1,0] neg_hi:[0,1]
    v_pk_add_f32 v[38:39], v[56:57], v[60:61] op_sel:[0,1] op_sel_hi:[1,0] neg_lo:[0,1]
    v_pk_add_f32 v[40:41], v[32:33], v[34:35]
    v_pk_add_f32 v[42:43], v[32:33], v[34:35] neg_lo:[0,1] neg_hi:[0,1]
    v_pk_add_f32 v[32:33], v[36:37], v[40:41]
    v_pk_add_f32 v[34:35], v[36:37], v[40:41] neg_lo:[0,1] neg_hi:[0,1]
    v_pk_add_f32 v[52:53], v[38:39], v[42:43] op_sel:[0,1] op_sel_hi:[1,0] neg_hi:[0,1]
    v_pk_add_f32 v[54:55], v[38:39], v[42:43] op_sel:[0,1] op_sel_hi:[1,0] neg_lo:[0,1]
    v_mul_f32 v10, 1.0, v24
    v_cos_f32 v36, v10
    v_sin_f32 v37, -v10
    v_mul_f32 v10, 2.0, v24
    v_cos_f32 v38, v10
    v_sin_f32 v39, -v10
    v_mul_f32 v10, 3.0, v24
    v_cos_f32 v40, v10
    v_sin_f32 v41, -v10
    v_mul_f32 v10, 4.0, v24
    v_cos_f32 v42, v10
    v_sin_f32 v43, -v10
    v_mul_f32 v10, 5.0, v24
    v_cos_f32 v56, v10
    v_sin_f32 v57, -v10
    v_mul_f32 v10, 6.0, v24
    v_cos_f32 v58, v10
    v_sin_f32 v59, -v10
    v_mul_f32 v10, 7.0, v24
    v_cos_f32 v60, v10
    v_sin_f32 v61, -v10
    s_nop 0
    v_pk_mul_f32 v[62:63], v[32:33], v[36:37] op_sel:[0,0] op_sel_hi:[0,1]
    v_pk_fma_f32 v[62:63], v[32:33], v[36:37], v[62:63] op_sel:[1,1,0] op_sel_hi:[1,0,1] neg_lo:[1,0,0]
    v_pk_mul_f32 v[32:33], v[48:49], v[38:39] op_sel:[0,0] op_sel_hi:[0,1]
    v_pk_fma_f32 v[32:33], v[48:49], v[38:39], v[32:33] op_sel:[1,1,0] op_sel_hi:[1,0,1] neg_lo:[1,0,0]
    v_pk_mul_f32 v[48:49], v[52:53], v[40:41] op_sel:[0,0] op_sel_hi:[0,1]
    v_pk_fma_f32 v[48:49], v[52:53], v[40:41], v[48:49] op_sel:[1,1,0] op_sel_hi:[1,0,1] neg_lo:[1,0,0]
    v_pk_mul_f32 v[52:53], v[46:47], v[42:43] op_sel:[0,0] op_sel_hi:[0,1]
    v_pk_fma_f32 v[52:53], v[46:47], v[42:43], v[52:53] op_sel:[1,1,0] op_sel_hi:[1,0,1] neg_lo:[1,0,0]
    v_pk_mul_f32 v[46:47], v[34:35], v[56:57] op_sel:[0,0] op_sel_hi:[0,1]
    v_pk_fma_f32 v[46:47], v[34:35], v[56:57], v[46:47] op_sel:[1,1,0] op_sel_hi:[1,0,1] neg_lo:[1,0,0]
    v_pk_mul_f32 v[34:35], v[50:51], v[58:59] op_sel:[0,0] op_sel_hi:[0,1]
    v_pk_fma_f32 v[34:35], v[50:51], v[58:59], v[34:35] op_sel:[1,1,0] op_sel_hi:[1,0,1] neg_lo:[1,0,0]
    v_pk_mul_f32 v[50:51], v[54:55], v[60:61] op_sel:[0,0] op_sel_hi:[0,1]
    v_pk_fma_f32 v[50:51], v[54:55], v[60:61], v[50:51] op_sel:[1,1,0] op_sel_hi:[1,0,1] neg_lo:[1,0,0]
    ds_write_b64 v20, v[44:45] offset:0
    ds_write_b64 v20, v[62:63] offset:576
    ds_write_b64 v20, v[32:33] offset:1152
    ds_write_b64 v20, v[48:49] offset:1728
    ds_write_b64 v20, v[52:53] offset:2304
    ds_write_b64 v20, v[46:47] offset:2880
    ds_write_b64 v20, v[34:35] offset:3456
    ds_write_b64 v20, v[50:51] offset:4032
    s_waitcnt lgkmcnt(0)
    ds_read_b64 v[32:33], v21 offset:0
    ds_read_b64 v[34:35], v21 offset:64
    ds_read_b64 v[36:37], v21 offset:128
    ds_read_b64 v[38:39], v21 offset:192
    ds_read_b64 v[40:41], v21 offset:256
    ds_read_b64 v[42:43], v21 offset:320
    ds_read_b64 v[44:45], v21 offset:384
    ds_read_b64 v[46:47], v21 offset:448
    s_waitcnt lgkmcnt(0)
    v_pk_add_f32 v[48:49], v[32:33], v[40:41]
    v_pk_add_f32 v[50:51], v[34:35], v[42:43]
    v_pk_add_f32 v[52:53], v[36:37], v[44:45]
    v_pk_add_f32 v[54:55], v[38:39], v[46:47]
    v_pk_add_f32 v[56:57], v[32:33], v[40:41] neg_lo:[0,1] neg_hi:[0,1]
    v_pk_add_f32 v[58:59], v[34:35], v[42:43] neg_lo:[0,1] neg_hi:[0,1]
    v_pk_add_f32 v[60:61], v[36:37], v[44:45] neg_lo:[0,1] neg_hi:[0,1]
    v_pk_add_f32 v[62:63], v[38:39], v[46:47] neg_lo:[0,1] neg_hi:[0,1]
    v_pk_add_f32 v[32:33], v[58:59], v[58:59] op_sel:[0,1] op_sel_hi:[1,0] neg_hi:[0,1]
    v_pk_mul_f32 v[32:33], v[32:33], s[20:21]
    v_pk_add_f32 v[34:35], v[62:63], v[62:63] op_sel:[1,0] op_sel_hi:[0,1] neg_lo:[0,1] neg_hi:[1,1]
    v_pk_mul_f32 v[34:35], v[34:35], s[20:21]
    v_pk_add_f32 v[36:37], v[48:49], v[52:53]
    v_pk_add_f32 v[38:39], v[50:51], v[54:55]
    v_pk_add_f32 v[40:41], v[48:49], v[52:53] neg_lo:[0,1] neg_hi:[0,1]
    v_pk_add_f32 v[42:43], v[50:51], v[54:55] neg_lo:[0,1] neg_hi:[0,1]
    v_pk_add_f32 v[44:45], v[36:37], v[38:39]
    v_pk_add_f32 v[46:47], v[36:37], v[38:39] neg_lo:[0,1] neg_hi:[0,1]
    v_pk_add_f32 v[48:49], v[40:41], v[42:43] op_sel:[0,1] op_sel_hi:[1,0] neg_hi:[0,1]
    v_pk_add_f32 v[50:51], v[40:41], v[42:43] op_sel:[0,1] op_sel_hi:[1,0] neg_lo:[0,1]
    v_pk_add_f32 v[36:37], v[56:57], v[60:61] op_sel:[0,1] op_sel_hi:[1,0] neg_hi:[0,1]
    v_pk_add_f32 v[38:39], v[56:57], v[60:61] op_sel:[0,1] op_sel_hi:[1,0] neg_lo:[0,1]
    v_pk_add_f32 v[40:41], v[32:33], v[34:35]
    v_pk_add_f32 v[42:43], v[32:33], v[34:35] neg_lo:[0,1] neg_hi:[0,1]
    v_pk_add_f32 v[32:33], v[36:37], v[40:41]
    v_pk_add_f32 v[34:35], v[36:37], v[40:41] neg_lo:[0,1] neg_hi:[0,1]
    v_pk_add_f32 v[52:53], v[38:39], v[42:43] op_sel:[0,1] op_sel_hi:[1,0] neg_hi:[0,1]
    v_pk_add_f32 v[54:55], v[38:39], v[42:43] op_sel:[0,1] op_sel_hi:[1,0] neg_lo:[0,1]
    v_mul_f32 v10, 1.0, v25
    v_cos_f32 v36, v10
    v_sin_f32 v37, -v10
    v_mul_f32 v10, 2.0, v25
    v_cos_f32 v38, v10
    v_sin_f32 v39, -v10
    v_mul_f32 v10, 3.0, v25
    v_cos_f32 v40, v10
    v_sin_f32 v41, -v10
    v_mul_f32 v10, 4.0, v25
    v_cos_f32 v42, v10
    v_sin_f32 v43, -v10
    v_mul_f32 v10, 5.0, v25
    v_cos_f32 v56, v10
    v_sin_f32 v57, -v10
    v_mul_f32 v10, 6.0, v25
    v_cos_f32 v58, v10
    v_sin_f32 v59, -v10
    v_mul_f32 v10, 7.0, v25
    v_cos_f32 v60, v10
    v_sin_f32 v61, -v10
    s_nop 0
    v_pk_mul_f32 v[62:63], v[32:33], v[36:37] op_sel:[0,0] op_sel_hi:[0,1]
    v_pk_fma_f32 v[62:63], v[32:33], v[36:37], v[62:63] op_sel:[1,1,0] op_sel_hi:[1,0,1] neg_lo:[1,0,0]
    v_pk_mul_f32 v[32:33], v[48:49], v[38:39] op_sel:[0,0] op_sel_hi:[0,1]
    v_pk_fma_f32 v[32:33], v[48:49], v[38:39], v[32:33] op_sel:[1,1,0] op_sel_hi:[1,0,1] neg_lo:[1,0,0]
    v_pk_mul_f32 v[48:49], v[52:53], v[40:41] op_sel:[0,0] op_sel_hi:[0,1]
    v_pk_fma_f32 v[48:49], v[52:53], v[40:41], v[48:49] op_sel:[1,1,0] op_sel_hi:[1,0,1] neg_lo:[1,0,0]
    v_pk_mul_f32 v[52:53], v[46:47], v[42:43] op_sel:[0,0] op_sel_hi:[0,1]
    v_pk_fma_f32 v[52:53], v[46:47], v[42:43], v[52:53] op_sel:[1,1,0] op_sel_hi:[1,0,1] neg_lo:[1,0,0]
    v_pk_mul_f32 v[46:47], v[34:35], v[56:57] op_sel:[0,0] op_sel_hi:[0,1]
    v_pk_fma_f32 v[46:47], v[34:35], v[56:57], v[46:47] op_sel:[1,1,0] op_sel_hi:[1,0,1] neg_lo:[1,0,0]
    v_pk_mul_f32 v[34:35], v[50:51], v[58:59] op_sel:[0,0] op_sel_hi:[0,1]
    v_pk_fma_f32 v[34:35], v[50:51], v[58:59], v[34:35] op_sel:[1,1,0] op_sel_hi:[1,0,1] neg_lo:[1,0,0]
    v_pk_mul_f32 v[50:51], v[54:55], v[60:61] op_sel:[0,0] op_sel_hi:[0,1]
    v_pk_fma_f32 v[50:51], v[54:55], v[60:61], v[50:51] op_sel:[1,1,0] op_sel_hi:[1,0,1] neg_lo:[1,0,0]
    ds_write_b64 v22, v[44:45] offset:0
    ds_write_b64 v22, v[62:63] offset:72
    ds_write_b64 v22, v[32:33] offset:144
    ds_write_b64 v22, v[48:49] offset:216
    ds_write_b64 v22, v[52:53] offset:288
    ds_write_b64 v22, v[46:47] offset:360
    ds_write_b64 v22, v[34:35] offset:432
    ds_write_b64 v22, v[50:51] offset:504
    s_waitcnt lgkmcnt(0)
    ds_read_b64 v[32:33], v23 offset:0
    ds_read_b64 v[34:35], v23 offset:8
    ds_read_b64 v[36:37], v23 offset:16
    ds_read_b64 v[38:39], v23 offset:24
    ds_read_b64 v[40:41], v23 offset:32
    ds_read_b64 v[42:43], v23 offset:40
    ds_read_b64 v[44:45], v23 offset:48
    ds_read_b64 v[46:47], v23 offset:56
    s_waitcnt lgkmcnt(0)
    v_pk_add_f32 v[48:49], v[32:33], v[40:41]
    v_pk_add_f32 v[50:51], v[34:35], v[42:43]
    v_pk_add_f32 v[52:53], v[36:37], v[44:45]
    v_pk_add_f32 v[54:55], v[38:39], v[46:47]
    v_pk_add_f32 v[56:57], v[32:33], v[40:41] neg_lo:[0,1] neg_hi:[0,1]
    v_pk_add_f32 v[58:59], v[34:35], v[42:43] neg_lo:[0,1] neg_hi:[0,1]
    v_pk_add_f32 v[60:61], v[36:37], v[44:45] neg_lo:[0,1] neg_hi:[0,1]
    v_pk_add_f32 v[62:63], v[38:39], v[46:47] neg_lo:[0,1] neg_hi:[0,1]
    v_pk_add_f32 v[32:33], v[58:59], v[58:59] op_sel:[0,1] op_sel_hi:[1,0] neg_hi:[0,1]
    v_pk_mul_f32 v[32:33], v[32:33], s[20:21]
    v_pk_add_f32 v[34:35], v[62:63], v[62:63] op_sel:[1,0] op_sel_hi:[0,1] neg_lo:[0,1] neg_hi:[1,1]
    v_pk_mul_f32 v[34:35], v[34:35], s[20:21]
    v_pk_add_f32 v[36:37], v[48:49], v[52:53]
    v_pk_add_f32 v[38:39], v[50:51], v[54:55]
    v_pk_add_f32 v[40:41], v[48:49], v[52:53] neg_lo:[0,1] neg_hi:[0,1]
    v_pk_add_f32 v[42:43], v[50:51], v[54:55] neg_lo:[0,1] neg_hi:[0,1]
    v_pk_add_f32 v[44:45], v[36:37], v[38:39]
    v_pk_add_f32 v[46:47], v[36:37], v[38:39] neg_lo:[0,1] neg_hi:[0,1]
    v_pk_add_f32 v[48:49], v[40:41], v[42:43] op_sel:[0,1] op_sel_hi:[1,0] neg_hi:[0,1]
    v_pk_add_f32 v[50:51], v[40:41], v[42:43] op_sel:[0,1] op_sel_hi:[1,0] neg_lo:[0,1]
    v_pk_add_f32 v[36:37], v[56:57], v[60:61] op_sel:[0,1] op_sel_hi:[1,0] neg_hi:[0,1]
    v_pk_add_f32 v[38:39], v[56:57], v[60:61] op_sel:[0,1] op_sel_hi:[1,0] neg_lo:[0,1]
    v_pk_add_f32 v[40:41], v[32:33], v[34:35]
    v_pk_add_f32 v[42:43], v[32:33], v[34:35] neg_lo:[0,1] neg_hi:[0,1]
    v_pk_add_f32 v[32:33], v[36:37], v[40:41]
    v_pk_add_f32 v[34:35], v[36:37], v[40:41] neg_lo:[0,1] neg_hi:[0,1]
    v_pk_add_f32 v[52:53], v[38:39], v[42:43] op_sel:[0,1] op_sel_hi:[1,0] neg_hi:[0,1]
    v_pk_add_f32 v[54:55], v[38:39], v[42:43] op_sel:[0,1] op_sel_hi:[1,0] neg_lo:[0,1]
    v_lshrrev_b32 v27, 3, v1
    v_and_b32 v28, 7, v1
    v_lshl_add_u32 v27, v28, 3, v27
    v_lshl_add_u32 v27, v27, 3, v2
    ds_write_b64 v27, v[44:45] offset:0
    ds_write_b64 v27, v[32:33] offset:512
    ds_write_b64 v27, v[48:49] offset:1024
    ds_write_b64 v27, v[52:53] offset:1536
    ds_write_b64 v27, v[46:47] offset:2048
    ds_write_b64 v27, v[34:35] offset:2560
    ds_write_b64 v27, v[50:51] offset:3072
    ds_write_b64 v27, v[54:55] offset:3584
    s_waitcnt lgkmcnt(0)
    v_sub_u32 v28, 512, v1
    v_and_b32 v28, 511, v28
    v_lshl_add_u32 v28, v28, 3, v2
    ds_read_b64 v[32:33], v20 offset:0
    ds_read_b64 v[42:43], v28
    ds_read_b64 v[34:35], v20 offset:512
    ds_read_b64 v[36:37], v20 offset:1024
    ds_read_b64 v[38:39], v20 offset:1536
    v_sub_u32 v29, 512, v1
    v_lshl_add_u32 v29, v29, 3, v2
    v_subrev_u32 v29, 2048, v29
    ds_read_b64 v[44:45], v29 offset:1536
    ds_read_b64 v[46:47], v29 offset:1024
    ds_read_b64 v[48:49], v29 offset:512
    ds_read_b64 v[40:41], v2 offset:2048
    s_waitcnt lgkmcnt(0)
    s_lshl_b32 s3, s2, 6
    v_lshlrev_b32 v30, 4, v3
    v_lshl_add_u32 v30, v1, 14, v30
    v_add_u32 v30, s3, v30
    v_add_f32 v100, v32, v42
    v_sub_f32 v101, v33, v43
    v_add_f32 v102, v33, v43
    v_sub_f32 v103, v42, v32
    s_mov_b32 s3, 0
    buffer_store_dwordx4 v[100:103], v30, s[24:27], s3 offen
    v_add_f32 v104, v34, v44
    v_sub_f32 v105, v35, v45
    v_add_f32 v106, v35, v45
    v_sub_f32 v107, v44, v34
    s_mov_b32 s3, 1048576
    buffer_store_dwordx4 v[104:107], v30, s[24:27], s3 offen
    v_add_f32 v108, v36, v46
    v_sub_f32 v109, v37, v47
    v_add_f32 v110, v37, v47
    v_sub_f32 v111, v46, v36
    s_mov_b32 s3, 2097152
    buffer_store_dwordx4 v[108:111], v30, s[24:27], s3 offen
    v_add_f32 v112, v38, v48
    v_sub_f32 v113, v39, v49
    v_add_f32 v114, v39, v49
    v_sub_f32 v115, v48, v38
    s_mov_b32 s3, 3145728
    buffer_store_dwordx4 v[112:115], v30, s[24:27], s3 offen
    v_add_f32 v116, v40, v40
    v_mov_b32 v117, 0
    v_add_f32 v118, v41, v41
    v_mov_b32 v119, 0
    v_cmp_eq_u32 vcc, 0, v1
    s_and_saveexec_b64 s[32:33], vcc
    s_mov_b32 s3, 4194304
    buffer_store_dwordx4 v[116:119], v30, s[24:27], s3 offen
    s_mov_b64 exec, s[32:33]
    s_endpgm
k1_kernel_side:
    s_cmp_ge_u32 s2, 320
    s_cbranch_scc1 k1_kernel_wts
    s_mov_b32 s28, s6
    s_and_b32 s29, s7, 0xffff
    s_mov_b32 s30, 1052672
    s_mov_b32 s31, 0x00020000
    s_mov_b32 s32, s8
    s_and_b32 s33, s9, 0xffff
    s_mov_b32 s34, 1052672
    s_mov_b32 s35, 0x00020000
    s_sub_u32 s3, s2, 256
    s_mul_i32 s36, s3, 16448
    v_lshlrev_b32 v1, 4, v0
    v_add_u32 v2, s36, v1
    buffer_load_dwordx4 v[8:11], v2, s[28:31], 0 offen offset:0
    buffer_load_dwordx4 v[32:35], v2, s[32:35], 0 offen offset:0
    s_add_u32 s99, 0, 4096
    buffer_load_dwordx4 v[12:15], v2, s[28:31], s99 offen offset:0
    s_add_u32 s99, 0, 4096
    buffer_load_dwordx4 v[36:39], v2, s[32:35], s99 offen offset:0
    s_add_u32 s99, 0, 8192
    buffer_load_dwordx4 v[16:19], v2, s[28:31], s99 offen offset:0
    s_add_u32 s99, 0, 8192
    buffer_load_dwordx4 v[40:43], v2, s[32:35], s99 offen offset:0
    s_add_u32 s99, 0, 12288
    buffer_load_dwordx4 v[20:23], v2, s[28:31], s99 offen offset:0
    s_add_u32 s99, 0, 12288
    buffer_load_dwordx4 v[44:47], v2, s[32:35], s99 offen offset:0
    v_add_u32 v3, 16384, v2
    buffer_load_dwordx4 v[24:27], v3, s[28:31], 0 offen
    buffer_load_dwordx4 v[48:51], v3, s[32:35], 0 offen
    s_waitcnt vmcnt(0)
    ds_write_b128 v1, v[8:11] offset:0
    ds_write_b128 v1, v[32:35] offset:16448
    ds_write_b128 v1, v[12:15] offset:4096
    ds_write_b128 v1, v[36:39] offset:20544
    ds_write_b128 v1, v[16:19] offset:8192
    ds_write_b128 v1, v[40:43] offset:24640
    ds_write_b128 v1, v[20:23] offset:12288
    ds_write_b128 v1, v[44:47] offset:28736
    v_cmp_gt_u32 vcc, 4, v0
    s_and_saveexec_b64 s[38:39], vcc
    ds_write_b128 v1, v[24:27] offset:16384
    ds_write_b128 v1, v[48:51] offset:32832
    s_mov_b64 exec, s[38:39]
    s_waitcnt lgkmcnt(0)
    s_barrier
    v_and_b32 v4, 31, v0
    v_lshrrev_b32 v5, 5, v0
    v_mul_u32_u24 v6, 514, v4
    v_lshl_add_u32 v6, v5, 1, v6
    s_lshl_b32 s37, s3, 7
    v_lshlrev_b32 v7, 13, v5
    v_lshl_add_u32 v7, v4, 2, v7
    v_add_u32 v7, s37, v7
    v_add_u32 v7, 4259840, v7
    ds_read_u16 v8, v6 offset:0
    ds_read_u16 v60, v6 offset:16448
    s_waitcnt lgkmcnt(0)
    v_lshl_or_b32 v8, v60, 16, v8
    s_mov_b32 s40, 0
    buffer_store_dword v8, v7, s[24:27], s40 offen
    ds_read_u16 v9, v6 offset:16
    ds_read_u16 v60, v6 offset:16464
    s_waitcnt lgkmcnt(0)
    v_lshl_or_b32 v9, v60, 16, v9
    s_mov_b32 s40, 65536
    buffer_store_dword v9, v7, s[24:27], s40 offen
    ds_read_u16 v10, v6 offset:32
    ds_read_u16 v60, v6 offset:16480
    s_waitcnt lgkmcnt(0)
    v_lshl_or_b32 v10, v60, 16, v10
    s_mov_b32 s40, 131072
    buffer_store_dword v10, v7, s[24:27], s40 offen
    ds_read_u16 v11, v6 offset:48
    ds_read_u16 v60, v6 offset:16496
    s_waitcnt lgkmcnt(0)
    v_lshl_or_b32 v11, v60, 16, v11
    s_mov_b32 s40, 196608
    buffer_store_dword v11, v7, s[24:27], s40 offen
    ds_read_u16 v12, v6 offset:64
    ds_read_u16 v60, v6 offset:16512
    s_waitcnt lgkmcnt(0)
    v_lshl_or_b32 v12, v60, 16, v12
    s_mov_b32 s40, 262144
    buffer_store_dword v12, v7, s[24:27], s40 offen
    ds_read_u16 v13, v6 offset:80
    ds_read_u16 v60, v6 offset:16528
    s_waitcnt lgkmcnt(0)
    v_lshl_or_b32 v13, v60, 16, v13
    s_mov_b32 s40, 327680
    buffer_store_dword v13, v7, s[24:27], s40 offen
    ds_read_u16 v14, v6 offset:96
    ds_read_u16 v60, v6 offset:16544
    s_waitcnt lgkmcnt(0)
    v_lshl_or_b32 v14, v60, 16, v14
    s_mov_b32 s40, 393216
    buffer_store_dword v14, v7, s[24:27], s40 offen
    ds_read_u16 v15, v6 offset:112
    ds_read_u16 v60, v6 offset:16560
    s_waitcnt lgkmcnt(0)
    v_lshl_or_b32 v15, v60, 16, v15
    s_mov_b32 s40, 458752
    buffer_store_dword v15, v7, s[24:27], s40 offen
    ds_read_u16 v16, v6 offset:128
    ds_read_u16 v60, v6 offset:16576
    s_waitcnt lgkmcnt(0)
    v_lshl_or_b32 v16, v60, 16, v16
    s_mov_b32 s40, 524288
    buffer_store_dword v16, v7, s[24:27], s40 offen
    ds_read_u16 v17, v6 offset:144
    ds_read_u16 v60, v6 offset:16592
    s_waitcnt lgkmcnt(0)
    v_lshl_or_b32 v17, v60, 16, v17
    s_mov_b32 s40, 589824
    buffer_store_dword v17, v7, s[24:27], s40 offen
    ds_read_u16 v18, v6 offset:160
    ds_read_u16 v60, v6 offset:16608
    s_waitcnt lgkmcnt(0)
    v_lshl_or_b32 v18, v60, 16, v18
    s_mov_b32 s40, 655360
    buffer_store_dword v18, v7, s[24:27], s40 offen
    ds_read_u16 v19, v6 offset:176
    ds_read_u16 v60, v6 offset:16624
    s_waitcnt lgkmcnt(0)
    v_lshl_or_b32 v19, v60, 16, v19
    s_mov_b32 s40, 720896
    buffer_store_dword v19, v7, s[24:27], s40 offen
    ds_read_u16 v20, v6 offset:192
    ds_read_u16 v60, v6 offset:16640
    s_waitcnt lgkmcnt(0)
    v_lshl_or_b32 v20, v60, 16, v20
    s_mov_b32 s40, 786432
    buffer_store_dword v20, v7, s[24:27], s40 offen
    ds_read_u16 v21, v6 offset:208
    ds_read_u16 v60, v6 offset:16656
    s_waitcnt lgkmcnt(0)
    v_lshl_or_b32 v21, v60, 16, v21
    s_mov_b32 s40, 851968
    buffer_store_dword v21, v7, s[24:27], s40 offen
    ds_read_u16 v22, v6 offset:224
    ds_read_u16 v60, v6 offset:16672
    s_waitcnt lgkmcnt(0)
    v_lshl_or_b32 v22, v60, 16, v22
    s_mov_b32 s40, 917504
    buffer_store_dword v22, v7, s[24:27], s40 offen
    ds_read_u16 v23, v6 offset:240
    ds_read_u16 v60, v6 offset:16688
    s_waitcnt lgkmcnt(0)
    v_lshl_or_b32 v23, v60, 16, v23
    s_mov_b32 s40, 983040
    buffer_store_dword v23, v7, s[24:27], s40 offen
    ds_read_u16 v24, v6 offset:256
    ds_read_u16 v60, v6 offset:16704
    s_waitcnt lgkmcnt(0)
    v_lshl_or_b32 v24, v60, 16, v24
    s_mov_b32 s40, 1048576
    buffer_store_dword v24, v7, s[24:27], s40 offen
    ds_read_u16 v25, v6 offset:272
    ds_read_u16 v60, v6 offset:16720
    s_waitcnt lgkmcnt(0)
    v_lshl_or_b32 v25, v60, 16, v25
    s_mov_b32 s40, 1114112
    buffer_store_dword v25, v7, s[24:27], s40 offen
    ds_read_u16 v26, v6 offset:288
    ds_read_u16 v60, v6 offset:16736
    s_waitcnt lgkmcnt(0)
    v_lshl_or_b32 v26, v60, 16, v26
    s_mov_b32 s40, 1179648
    buffer_store_dword v26, v7, s[24:27], s40 offen
    ds_read_u16 v27, v6 offset:304
    ds_read_u16 v60, v6 offset:16752
    s_waitcnt lgkmcnt(0)
    v_lshl_or_b32 v27, v60, 16, v27
    s_mov_b32 s40, 1245184
    buffer_store_dword v27, v7, s[24:27], s40 offen
    ds_read_u16 v28, v6 offset:320
    ds_read_u16 v60, v6 offset:16768
    s_waitcnt lgkmcnt(0)
    v_lshl_or_b32 v28, v60, 16, v28
    s_mov_b32 s40, 1310720
    buffer_store_dword v28, v7, s[24:27], s40 offen
    ds_read_u16 v29, v6 offset:336
    ds_read_u16 v60, v6 offset:16784
    s_waitcnt lgkmcnt(0)
    v_lshl_or_b32 v29, v60, 16, v29
    s_mov_b32 s40, 1376256
    buffer_store_dword v29, v7, s[24:27], s40 offen
    ds_read_u16 v30, v6 offset:352
    ds_read_u16 v60, v6 offset:16800
    s_waitcnt lgkmcnt(0)
    v_lshl_or_b32 v30, v60, 16, v30
    s_mov_b32 s40, 1441792
    buffer_store_dword v30, v7, s[24:27], s40 offen
    ds_read_u16 v31, v6 offset:368
    ds_read_u16 v60, v6 offset:16816
    s_waitcnt lgkmcnt(0)
    v_lshl_or_b32 v31, v60, 16, v31
    s_mov_b32 s40, 1507328
    buffer_store_dword v31, v7, s[24:27], s40 offen
    ds_read_u16 v32, v6 offset:384
    ds_read_u16 v60, v6 offset:16832
    s_waitcnt lgkmcnt(0)
    v_lshl_or_b32 v32, v60, 16, v32
    s_mov_b32 s40, 1572864
    buffer_store_dword v32, v7, s[24:27], s40 offen
    ds_read_u16 v33, v6 offset:400
    ds_read_u16 v60, v6 offset:16848
    s_waitcnt lgkmcnt(0)
    v_lshl_or_b32 v33, v60, 16, v33
    s_mov_b32 s40, 1638400
    buffer_store_dword v33, v7, s[24:27], s40 offen
    ds_read_u16 v34, v6 offset:416
    ds_read_u16 v60, v6 offset:16864
    s_waitcnt lgkmcnt(0)
    v_lshl_or_b32 v34, v60, 16, v34
    s_mov_b32 s40, 1703936
    buffer_store_dword v34, v7, s[24:27], s40 offen
    ds_read_u16 v35, v6 offset:432
    ds_read_u16 v60, v6 offset:16880
    s_waitcnt lgkmcnt(0)
    v_lshl_or_b32 v35, v60, 16, v35
    s_mov_b32 s40, 1769472
    buffer_store_dword v35, v7, s[24:27], s40 offen
    ds_read_u16 v36, v6 offset:448
    ds_read_u16 v60, v6 offset:16896
    s_waitcnt lgkmcnt(0)
    v_lshl_or_b32 v36, v60, 16, v36
    s_mov_b32 s40, 1835008
    buffer_store_dword v36, v7, s[24:27], s40 offen
    ds_read_u16 v37, v6 offset:464
    ds_read_u16 v60, v6 offset:16912
    s_waitcnt lgkmcnt(0)
    v_lshl_or_b32 v37, v60, 16, v37
    s_mov_b32 s40, 1900544
    buffer_store_dword v37, v7, s[24:27], s40 offen
    ds_read_u16 v38, v6 offset:480
    ds_read_u16 v60, v6 offset:16928
    s_waitcnt lgkmcnt(0)
    v_lshl_or_b32 v38, v60, 16, v38
    s_mov_b32 s40, 1966080
    buffer_store_dword v38, v7, s[24:27], s40 offen
    ds_read_u16 v39, v6 offset:496
    ds_read_u16 v60, v6 offset:16944
    s_waitcnt lgkmcnt(0)
    v_lshl_or_b32 v39, v60, 16, v39
    s_mov_b32 s40, 2031616
    buffer_store_dword v39, v7, s[24:27], s40 offen
    v_cmp_gt_u32 vcc, 32, v0
    s_and_saveexec_b64 s[38:39], vcc
    ds_read_u16 v40, v6 offset:512
    ds_read_u16 v60, v6 offset:16960
    s_waitcnt lgkmcnt(0)
    v_lshl_or_b32 v40, v60, 16, v40
    s_mov_b32 s40, 2097152
    buffer_store_dword v40, v7, s[24:27], s40 offen
    s_mov_b64 exec, s[38:39]
    s_endpgm
k1_kernel_wts:
    s_sub_u32 s3, s2, 320
    s_cmp_ge_u32 s3, 64
    s_cbranch_scc1 k1_kernel_wd
    s_lshr_b32 s36, s3, 5
    s_and_b32 s37, s3, 31
    s_cmp_eq_u32 s36, 0
    s_cselect_b32 s38, s12, s14
    s_cselect_b32 s39, s13, s15
    s_mov_b32 s28, s38
    s_and_b32 s29, s39, 0xffff
    s_mov_b32 s30, 1409024
    s_mov_b32 s31, 0x00020000
    s_mul_i32 s40, s37, 44032
    v_lshlrev_b32 v1, 4, v0
    v_add_u32 v2, s40, v1
    buffer_load_dwordx4 v[8:11], v2, s[28:31], 0 offen offset:0
    s_add_u32 s99, 0, 4096
    buffer_load_dwordx4 v[12:15], v2, s[28:31], s99 offen offset:0
    s_add_u32 s99, 0, 8192
    buffer_load_dwordx4 v[16:19], v2, s[28:31], s99 offen offset:0
    s_add_u32 s99, 0, 12288
    buffer_load_dwordx4 v[20:23], v2, s[28:31], s99 offen offset:0
    s_add_u32 s99, 0, 16384
    buffer_load_dwordx4 v[24:27], v2, s[28:31], s99 offen offset:0
    s_add_u32 s99, 0, 20480
    buffer_load_dwordx4 v[28:31], v2, s[28:31], s99 offen offset:0
    s_add_u32 s99, 0, 24576
    buffer_load_dwordx4 v[32:35], v2, s[28:31], s99 offen offset:0
    s_add_u32 s99, 0, 28672
    buffer_load_dwordx4 v[36:39], v2, s[28:31], s99 offen offset:0
    s_add_u32 s99, 0, 32768
    buffer_load_dwordx4 v[40:43], v2, s[28:31], s99 offen offset:0
    s_add_u32 s99, 0, 36864
    buffer_load_dwordx4 v[44:47], v2, s[28:31], s99 offen offset:0
    s_add_u32 s99, 0, 40960
    buffer_load_dwordx4 v[48:51], v2, s[28:31], s99 offen offset:0
    s_waitcnt vmcnt(0)
    ds_write_b128 v1, v[8:11] offset:0
    ds_write_b128 v1, v[12:15] offset:4096
    ds_write_b128 v1, v[16:19] offset:8192
    ds_write_b128 v1, v[20:23] offset:12288
    ds_write_b128 v1, v[24:27] offset:16384
    ds_write_b128 v1, v[28:31] offset:20480
    ds_write_b128 v1, v[32:35] offset:24576
    ds_write_b128 v1, v[36:39] offset:28672
    ds_write_b128 v1, v[40:43] offset:32768
    ds_write_b128 v1, v[44:47] offset:36864
    v_cmp_gt_u32 vcc, 192, v0
    s_and_saveexec_b64 s[38:39], vcc
    ds_write_b128 v1, v[48:51] offset:40960
    s_mov_b64 exec, s[38:39]
    s_waitcnt lgkmcnt(0)
    s_barrier
    v_and_b32 v3, 31, v0
    v_bfe_u32 v4, v0, 5, 1
    v_lshrrev_b32 v5, 6, v0
    v_mul_u32_u24 v6, 22016, v4
    v_lshl_add_u32 v6, v3, 1, v6
    v_lshl_add_u32 v6, v5, 6, v6
    v_and_b32 v7, 63, v0
    v_lshlrev_b32 v7, 4, v7
    s_mul_i32 s41, s37, 6144
    s_mul_i32 s42, s36, 3072
    s_add_u32 s41, s41, s42
    s_add_u32 s41, s41, 16384000
    ds_read_u16 v8, v6 offset:0
    ds_read_u16 v60, v6 offset:2752
    ds_read_u16 v9, v6 offset:5504
    ds_read_u16 v61, v6 offset:8256
    ds_read_u16 v10, v6 offset:11008
    ds_read_u16 v62, v6 offset:13760
    ds_read_u16 v11, v6 offset:16512
    ds_read_u16 v63, v6 offset:19264
    v_add_u32 v12, 0, v5
    v_mul_u32_u24 v13, 21846, v12
    v_lshrrev_b32 v13, 16, v13
    v_mul_u32_u24 v14, 3, v13
    v_sub_u32 v14, v12, v14
    v_mul_u32_u24 v13, 196608, v13
    v_lshl_add_u32 v13, v14, 10, v13
    v_add_u32 v13, v13, v7
    s_waitcnt lgkmcnt(0)
    v_lshl_or_b32 v8, v60, 16, v8
    v_lshl_or_b32 v9, v61, 16, v9
    v_lshl_or_b32 v10, v62, 16, v10
    v_lshl_or_b32 v11, v63, 16, v11
    buffer_store_dwordx4 v[8:11], v13, s[24:27], s41 offen
    s_waitcnt vmcnt(0)
    ds_read_u16 v8, v6 offset:256
    ds_read_u16 v60, v6 offset:3008
    ds_read_u16 v9, v6 offset:5760
    ds_read_u16 v61, v6 offset:8512
    ds_read_u16 v10, v6 offset:11264
    ds_read_u16 v62, v6 offset:14016
    ds_read_u16 v11, v6 offset:16768
    ds_read_u16 v63, v6 offset:19520
    v_add_u32 v12, 4, v5
    v_mul_u32_u24 v13, 21846, v12
    v_lshrrev_b32 v13, 16, v13
    v_mul_u32_u24 v14, 3, v13
    v_sub_u32 v14, v12, v14
    v_mul_u32_u24 v13, 196608, v13
    v_lshl_add_u32 v13, v14, 10, v13
    v_add_u32 v13, v13, v7
    s_waitcnt lgkmcnt(0)
    v_lshl_or_b32 v8, v60, 16, v8
    v_lshl_or_b32 v9, v61, 16, v9
    v_lshl_or_b32 v10, v62, 16, v10
    v_lshl_or_b32 v11, v63, 16, v11
    buffer_store_dwordx4 v[8:11], v13, s[24:27], s41 offen
    s_waitcnt vmcnt(0)
    ds_read_u16 v8, v6 offset:512
    ds_read_u16 v60, v6 offset:3264
    ds_read_u16 v9, v6 offset:6016
    ds_read_u16 v61, v6 offset:8768
    ds_read_u16 v10, v6 offset:11520
    ds_read_u16 v62, v6 offset:14272
    ds_read_u16 v11, v6 offset:17024
    ds_read_u16 v63, v6 offset:19776
    v_add_u32 v12, 8, v5
    v_mul_u32_u24 v13, 21846, v12
    v_lshrrev_b32 v13, 16, v13
    v_mul_u32_u24 v14, 3, v13
    v_sub_u32 v14, v12, v14
    v_mul_u32_u24 v13, 196608, v13
    v_lshl_add_u32 v13, v14, 10, v13
    v_add_u32 v13, v13, v7
    s_waitcnt lgkmcnt(0)
    v_lshl_or_b32 v8, v60, 16, v8
    v_lshl_or_b32 v9, v61, 16, v9
    v_lshl_or_b32 v10, v62, 16, v10
    v_lshl_or_b32 v11, v63, 16, v11
    buffer_store_dwordx4 v[8:11], v13, s[24:27], s41 offen
    s_waitcnt vmcnt(0)
    ds_read_u16 v8, v6 offset:768
    ds_read_u16 v60, v6 offset:3520
    ds_read_u16 v9, v6 offset:6272
    ds_read_u16 v61, v6 offset:9024
    ds_read_u16 v10, v6 offset:11776
    ds_read_u16 v62, v6 offset:14528
    ds_read_u16 v11, v6 offset:17280
    ds_read_u16 v63, v6 offset:20032
    v_add_u32 v12, 12, v5
    v_mul_u32_u24 v13, 21846, v12
    v_lshrrev_b32 v13, 16, v13
    v_mul_u32_u24 v14, 3, v13
    v_sub_u32 v14, v12, v14
    v_mul_u32_u24 v13, 196608, v13
    v_lshl_add_u32 v13, v14, 10, v13
    v_add_u32 v13, v13, v7
    s_waitcnt lgkmcnt(0)
    v_lshl_or_b32 v8, v60, 16, v8
    v_lshl_or_b32 v9, v61, 16, v9
    v_lshl_or_b32 v10, v62, 16, v10
    v_lshl_or_b32 v11, v63, 16, v11
    buffer_store_dwordx4 v[8:11], v13, s[24:27], s41 offen
    s_waitcnt vmcnt(0)
    ds_read_u16 v8, v6 offset:1024
    ds_read_u16 v60, v6 offset:3776
    ds_read_u16 v9, v6 offset:6528
    ds_read_u16 v61, v6 offset:9280
    ds_read_u16 v10, v6 offset:12032
    ds_read_u16 v62, v6 offset:14784
    ds_read_u16 v11, v6 offset:17536
    ds_read_u16 v63, v6 offset:20288
    v_add_u32 v12, 16, v5
    v_mul_u32_u24 v13, 21846, v12
    v_lshrrev_b32 v13, 16, v13
    v_mul_u32_u24 v14, 3, v13
    v_sub_u32 v14, v12, v14
    v_mul_u32_u24 v13, 196608, v13
    v_lshl_add_u32 v13, v14, 10, v13
    v_add_u32 v13, v13, v7
    s_waitcnt lgkmcnt(0)
    v_lshl_or_b32 v8, v60, 16, v8
    v_lshl_or_b32 v9, v61, 16, v9
    v_lshl_or_b32 v10, v62, 16, v10
    v_lshl_or_b32 v11, v63, 16, v11
    buffer_store_dwordx4 v[8:11], v13, s[24:27], s41 offen
    s_waitcnt vmcnt(0)
    ds_read_u16 v8, v6 offset:1280
    ds_read_u16 v60, v6 offset:4032
    ds_read_u16 v9, v6 offset:6784
    ds_read_u16 v61, v6 offset:9536
    ds_read_u16 v10, v6 offset:12288
    ds_read_u16 v62, v6 offset:15040
    ds_read_u16 v11, v6 offset:17792
    ds_read_u16 v63, v6 offset:20544
    v_add_u32 v12, 20, v5
    v_mul_u32_u24 v13, 21846, v12
    v_lshrrev_b32 v13, 16, v13
    v_mul_u32_u24 v14, 3, v13
    v_sub_u32 v14, v12, v14
    v_mul_u32_u24 v13, 196608, v13
    v_lshl_add_u32 v13, v14, 10, v13
    v_add_u32 v13, v13, v7
    s_waitcnt lgkmcnt(0)
    v_lshl_or_b32 v8, v60, 16, v8
    v_lshl_or_b32 v9, v61, 16, v9
    v_lshl_or_b32 v10, v62, 16, v10
    v_lshl_or_b32 v11, v63, 16, v11
    buffer_store_dwordx4 v[8:11], v13, s[24:27], s41 offen
    s_waitcnt vmcnt(0)
    ds_read_u16 v8, v6 offset:1536
    ds_read_u16 v60, v6 offset:4288
    ds_read_u16 v9, v6 offset:7040
    ds_read_u16 v61, v6 offset:9792
    ds_read_u16 v10, v6 offset:12544
    ds_read_u16 v62, v6 offset:15296
    ds_read_u16 v11, v6 offset:18048
    ds_read_u16 v63, v6 offset:20800
    v_add_u32 v12, 24, v5
    v_mul_u32_u24 v13, 21846, v12
    v_lshrrev_b32 v13, 16, v13
    v_mul_u32_u24 v14, 3, v13
    v_sub_u32 v14, v12, v14
    v_mul_u32_u24 v13, 196608, v13
    v_lshl_add_u32 v13, v14, 10, v13
    v_add_u32 v13, v13, v7
    s_waitcnt lgkmcnt(0)
    v_lshl_or_b32 v8, v60, 16, v8
    v_lshl_or_b32 v9, v61, 16, v9
    v_lshl_or_b32 v10, v62, 16, v10
    v_lshl_or_b32 v11, v63, 16, v11
    buffer_store_dwordx4 v[8:11], v13, s[24:27], s41 offen
    s_waitcnt vmcnt(0)
    ds_read_u16 v8, v6 offset:1792
    ds_read_u16 v60, v6 offset:4544
    ds_read_u16 v9, v6 offset:7296
    ds_read_u16 v61, v6 offset:10048
    ds_read_u16 v10, v6 offset:12800
    ds_read_u16 v62, v6 offset:15552
    ds_read_u16 v11, v6 offset:18304
    ds_read_u16 v63, v6 offset:21056
    v_add_u32 v12, 28, v5
    v_mul_u32_u24 v13, 21846, v12
    v_lshrrev_b32 v13, 16, v13
    v_mul_u32_u24 v14, 3, v13
    v_sub_u32 v14, v12, v14
    v_mul_u32_u24 v13, 196608, v13
    v_lshl_add_u32 v13, v14, 10, v13
    v_add_u32 v13, v13, v7
    s_waitcnt lgkmcnt(0)
    v_lshl_or_b32 v8, v60, 16, v8
    v_lshl_or_b32 v9, v61, 16, v9
    v_lshl_or_b32 v10, v62, 16, v10
    v_lshl_or_b32 v11, v63, 16, v11
    buffer_store_dwordx4 v[8:11], v13, s[24:27], s41 offen
    s_waitcnt vmcnt(0)
    ds_read_u16 v8, v6 offset:2048
    ds_read_u16 v60, v6 offset:4800
    ds_read_u16 v9, v6 offset:7552
    ds_read_u16 v61, v6 offset:10304
    ds_read_u16 v10, v6 offset:13056
    ds_read_u16 v62, v6 offset:15808
    ds_read_u16 v11, v6 offset:18560
    ds_read_u16 v63, v6 offset:21312
    v_add_u32 v12, 32, v5
    v_mul_u32_u24 v13, 21846, v12
    v_lshrrev_b32 v13, 16, v13
    v_mul_u32_u24 v14, 3, v13
    v_sub_u32 v14, v12, v14
    v_mul_u32_u24 v13, 196608, v13
    v_lshl_add_u32 v13, v14, 10, v13
    v_add_u32 v13, v13, v7
    s_waitcnt lgkmcnt(0)
    v_lshl_or_b32 v8, v60, 16, v8
    v_lshl_or_b32 v9, v61, 16, v9
    v_lshl_or_b32 v10, v62, 16, v10
    v_lshl_or_b32 v11, v63, 16, v11
    buffer_store_dwordx4 v[8:11], v13, s[24:27], s41 offen
    s_waitcnt vmcnt(0)
    ds_read_u16 v8, v6 offset:2304
    ds_read_u16 v60, v6 offset:5056
    ds_read_u16 v9, v6 offset:7808
    ds_read_u16 v61, v6 offset:10560
    ds_read_u16 v10, v6 offset:13312
    ds_read_u16 v62, v6 offset:16064
    ds_read_u16 v11, v6 offset:18816
    ds_read_u16 v63, v6 offset:21568
    v_add_u32 v12, 36, v5
    v_mul_u32_u24 v13, 21846, v12
    v_lshrrev_b32 v13, 16, v13
    v_mul_u32_u24 v14, 3, v13
    v_sub_u32 v14, v12, v14
    v_mul_u32_u24 v13, 196608, v13
    v_lshl_add_u32 v13, v14, 10, v13
    v_add_u32 v13, v13, v7
    s_waitcnt lgkmcnt(0)
    v_lshl_or_b32 v8, v60, 16, v8
    v_lshl_or_b32 v9, v61, 16, v9
    v_lshl_or_b32 v10, v62, 16, v10
    v_lshl_or_b32 v11, v63, 16, v11
    buffer_store_dwordx4 v[8:11], v13, s[24:27], s41 offen
    s_waitcnt vmcnt(0)
    v_cmp_gt_u32 vcc, 192, v0
    s_and_saveexec_b64 s[38:39], vcc
    ds_read_u16 v8, v6 offset:2560
    ds_read_u16 v60, v6 offset:5312
    ds_read_u16 v9, v6 offset:8064
    ds_read_u16 v61, v6 offset:10816
    ds_read_u16 v10, v6 offset:13568
    ds_read_u16 v62, v6 offset:16320
    ds_read_u16 v11, v6 offset:19072
    ds_read_u16 v63, v6 offset:21824
    v_add_u32 v12, 40, v5
    v_mul_u32_u24 v13, 21846, v12
    v_lshrrev_b32 v13, 16, v13
    v_mul_u32_u24 v14, 3, v13
    v_sub_u32 v14, v12, v14
    v_mul_u32_u24 v13, 196608, v13
    v_lshl_add_u32 v13, v14, 10, v13
    v_add_u32 v13, v13, v7
    s_waitcnt lgkmcnt(0)
    v_lshl_or_b32 v8, v60, 16, v8
    v_lshl_or_b32 v9, v61, 16, v9
    v_lshl_or_b32 v10, v62, 16, v10
    v_lshl_or_b32 v11, v63, 16, v11
    buffer_store_dwordx4 v[8:11], v13, s[24:27], s41 offen
    s_waitcnt vmcnt(0)
    s_mov_b64 exec, s[38:39]
    s_endpgm
k1_kernel_wd:
    s_sub_u32 s37, s3, 64
    s_mov_b32 s28, s16
    s_and_b32 s29, s17, 0xffff
    s_mov_b32 s30, 1409024
    s_mov_b32 s31, 0x00020000
    s_lshl_b32 s40, s37, 14
    v_lshlrev_b32 v1, 4, v0
    v_add_u32 v2, s40, v1
    buffer_load_dwordx4 v[8:11], v2, s[28:31], 0 offen offset:0
    s_add_u32 s99, 0, 4096
    buffer_load_dwordx4 v[12:15], v2, s[28:31], s99 offen offset:0
    s_add_u32 s99, 0, 8192
    buffer_load_dwordx4 v[16:19], v2, s[28:31], s99 offen offset:0
    s_add_u32 s99, 0, 12288
    buffer_load_dwordx4 v[20:23], v2, s[28:31], s99 offen offset:0
    s_waitcnt vmcnt(0)
    v_lshrrev_b32 v3, 6, v0
    v_lshlrev_b32 v3, 4, v3
    v_add_u32 v3, v3, v1
    ds_write_b128 v3, v[8:11] offset:0
    v_lshrrev_b32 v3, 6, v0
    v_lshlrev_b32 v3, 4, v3
    v_add_u32 v3, v3, v1
    ds_write_b128 v3, v[12:15] offset:4160
    v_lshrrev_b32 v3, 6, v0
    v_lshlrev_b32 v3, 4, v3
    v_add_u32 v3, v3, v1
    ds_write_b128 v3, v[16:19] offset:8320
    v_lshrrev_b32 v3, 6, v0
    v_lshlrev_b32 v3, 4, v3
    v_add_u32 v3, v3, v1
    ds_write_b128 v3, v[20:23] offset:12480
    s_waitcnt lgkmcnt(0)
    s_barrier
    v_and_b32 v3, 31, v0
    v_bfe_u32 v4, v0, 5, 1
    v_lshrrev_b32 v5, 6, v0
    v_mul_u32_u24 v6, 8320, v4
    v_lshl_add_u32 v6, v3, 1, v6
    v_lshl_add_u32 v6, v5, 6, v6
    v_and_b32 v7, 63, v0
    v_lshlrev_b32 v7, 4, v7
    v_mul_u32_u24 v13, 88064, v5
    v_add_u32 v7, v7, v13
    s_lshl_b32 s41, s37, 10
    s_add_u32 s41, s41, 19333120
    ds_read_u16 v8, v6 offset:0
    ds_read_u16 v60, v6 offset:1040
    ds_read_u16 v9, v6 offset:2080
    ds_read_u16 v61, v6 offset:3120
    ds_read_u16 v10, v6 offset:4160
    ds_read_u16 v62, v6 offset:5200
    ds_read_u16 v11, v6 offset:6240
    ds_read_u16 v63, v6 offset:7280
    s_waitcnt lgkmcnt(0)
    v_lshl_or_b32 v8, v60, 16, v8
    v_lshl_or_b32 v9, v61, 16, v9
    v_lshl_or_b32 v10, v62, 16, v10
    v_lshl_or_b32 v11, v63, 16, v11
    buffer_store_dwordx4 v[8:11], v7, s[24:27], s41 offen offset:0
    s_add_u32 s41, s41, 352256
    s_waitcnt vmcnt(0)
    ds_read_u16 v8, v6 offset:256
    ds_read_u16 v60, v6 offset:1296
    ds_read_u16 v9, v6 offset:2336
    ds_read_u16 v61, v6 offset:3376
    ds_read_u16 v10, v6 offset:4416
    ds_read_u16 v62, v6 offset:5456
    ds_read_u16 v11, v6 offset:6496
    ds_read_u16 v63, v6 offset:7536
    s_waitcnt lgkmcnt(0)
    v_lshl_or_b32 v8, v60, 16, v8
    v_lshl_or_b32 v9, v61, 16, v9
    v_lshl_or_b32 v10, v62, 16, v10
    v_lshl_or_b32 v11, v63, 16, v11
    buffer_store_dwordx4 v[8:11], v7, s[24:27], s41 offen offset:0
    s_add_u32 s41, s41, 352256
    s_waitcnt vmcnt(0)
    ds_read_u16 v8, v6 offset:512
    ds_read_u16 v60, v6 offset:1552
    ds_read_u16 v9, v6 offset:2592
    ds_read_u16 v61, v6 offset:3632
    ds_read_u16 v10, v6 offset:4672
    ds_read_u16 v62, v6 offset:5712
    ds_read_u16 v11, v6 offset:6752
    ds_read_u16 v63, v6 offset:7792
    s_waitcnt lgkmcnt(0)
    v_lshl_or_b32 v8, v60, 16, v8
    v_lshl_or_b32 v9, v61, 16, v9
    v_lshl_or_b32 v10, v62, 16, v10
    v_lshl_or_b32 v11, v63, 16, v11
    buffer_store_dwordx4 v[8:11], v7, s[24:27], s41 offen offset:0
    s_add_u32 s41, s41, 352256
    s_waitcnt vmcnt(0)
    ds_read_u16 v8, v6 offset:768
    ds_read_u16 v60, v6 offset:1808
    ds_read_u16 v9, v6 offset:2848
    ds_read_u16 v61, v6 offset:3888
    ds_read_u16 v10, v6 offset:4928
    ds_read_u16 v62, v6 offset:5968
    ds_read_u16 v11, v6 offset:7008
    ds_read_u16 v63, v6 offset:8048
    s_waitcnt lgkmcnt(0)
    v_lshl_or_b32 v8, v60, 16, v8
    v_lshl_or_b32 v9, v61, 16, v9
    v_lshl_or_b32 v10, v62, 16, v10
    v_lshl_or_b32 v11, v63, 16, v11
    buffer_store_dwordx4 v[8:11], v7, s[24:27], s41 offen offset:0
    s_add_u32 s41, s41, 352256
    s_waitcnt vmcnt(0)
k1_kernel_end:
    s_endpgm
.globl k2_kernel
.p2align 8
.type k2_kernel,@function
k2_kernel:
    s_load_dwordx2 s[10:11], s[0:1], 72
    s_mov_b32 s20, 0x3f3504f3
    s_mov_b32 s21, 0x3f3504f3
    s_cmp_ge_u32 s2, 257
    s_cbranch_scc1 k2_kernel_end
    s_waitcnt lgkmcnt(0)
    s_mov_b32 s24, s10
    s_and_b32 s25, s11, 0xffff
    s_mov_b32 s26, 20971520
    s_mov_b32 s27, 0x00020000
    s_lshl_b32 s3, s2, 14
    s_lshl_b32 s4, s2, 13
    s_add_u32 s4, s4, 4259840
    v_lshlrev_b32 v1, 3, v0
    buffer_load_dwordx2 v[32:33], v1, s[24:27], s3 offen offset:0
    buffer_load_dwordx2 v[34:35], v1, s[24:27], s3 offen offset:2048
    s_add_u32 s99, s3, 4096
    buffer_load_dwordx2 v[36:37], v1, s[24:27], s99 offen offset:0
    s_add_u32 s99, s3, 4096
    buffer_load_dwordx2 v[38:39], v1, s[24:27], s99 offen offset:2048
    s_add_u32 s99, s3, 8192
    buffer_load_dwordx2 v[40:41], v1, s[24:27], s99 offen offset:0
    s_add_u32 s99, s3, 8192
    buffer_load_dwordx2 v[42:43], v1, s[24:27], s99 offen offset:2048
    s_add_u32 s99, s3, 12288
    buffer_load_dwordx2 v[44:45], v1, s[24:27], s99 offen offset:0
    s_add_u32 s99, s3, 12288
    buffer_load_dwordx2 v[46:47], v1, s[24:27], s99 offen offset:2048
    v_and_b32 v2, 63, v0
    v_lshrrev_b32 v3, 6, v0
    v_lshrrev_b32 v4, 3, v2
    v_and_b32 v5, 7, v2
    v_lshl_add_u32 v4, v5, 3, v4
    v_lshl_add_u32 v4, v3, 7, v4
    v_lshlrev_b32 v4, 2, v4
    buffer_load_dword v16, v4, s[24:27], s4 offen offset:0
    buffer_load_dword v17, v4, s[24:27], s4 offen offset:2048
    s_add_u32 s99, s4, 4096
    buffer_load_dword v18, v4, s[24:27], s99 offen offset:0
    s_add_u32 s99, s4, 4096
    buffer_load_dword v19, v4, s[24:27], s99 offen offset:2048
    buffer_load_dword v20, v4, s[24:27], s4 offen offset:256
    buffer_load_dword v21, v4, s[24:27], s4 offen offset:2304
    s_add_u32 s99, s4, 4096
    buffer_load_dword v22, v4, s[24:27], s99 offen offset:256
    s_add_u32 s99, s4, 4096
    buffer_load_dword v23, v4, s[24:27], s99 offen offset:2304
    v_and_b32 v5, 31, v0
    v_lshrrev_b32 v6, 5, v0
    v_lshlrev_b32 v7, 11, v6
    v_lshl_add_u32 v7, v5, 3, v7
    v_mul_u32_u24 v8, 2304, v6
    v_lshl_add_u32 v8, v5, 3, v8
    v_bfe_u32 v9, v0, 2, 3
    v_mul_u32_u24 v10, 288, v9
    v_mul_u32_u24 v11, 2304, v6
    v_add_u32 v10, v10, v11
    v_and_b32 v11, 3, v0
    v_lshl_add_u32 v10, v11, 3, v10
    v_mul_u32_u24 v12, 576, v11
    v_lshl_add_u32 v13, v6, 3, v9
    v_lshl_add_u32 v12, v13, 3, v12
    v_mul_u32_u24 v13, 4608, v3
    v_lshl_add_u32 v13, v2, 3, v13
    v_cvt_f32_u32 v14, v0
    v_mul_f32 v14, 0x3a000000, v14
    v_cvt_f32_u32 v15, v5
    v_mul_f32 v15, 0x3b800000, v15
    v_cvt_f32_u32 v24, v11
    v_mul_f32 v24, 0x3d000000, v24
    v_mul_f32 v25, 1.0, v14
    v_cos_f32 v48, v25
    v_sin_f32 v49, -v25
    v_mul_f32 v25, 2.0, v14
    v_cos_f32 v50, v25
    v_sin_f32 v51, -v25
    v_mul_f32 v25, 3.0, v14
    v_cos_f32 v52, v25
    v_sin_f32 v53, -v25
    v_mul_f32 v25, 4.0, v14
    v_cos_f32 v54, v25
    v_sin_f32 v55, -v25
    v_mul_f32 v25, 5.0, v14
    v_cos_f32 v56, v25
    v_sin_f32 v57, -v25
    v_mul_f32 v25, 6.0, v14
    v_cos_f32 v58, v25
    v_sin_f32 v59, -v25
    v_mul_f32 v25, 7.0, v14
    v_cos_f32 v60, v25
    v_sin_f32 v61, -v25
    s_nop 0
    v_mul_f32 v25, 1.0, v15
    v_cos_f32 v62, v25
    v_sin_f32 v63, -v25
    v_mul_f32 v25, 2.0, v15
    v_cos_f32 v64, v25
    v_sin_f32 v65, -v25
    v_mul_f32 v25, 3.0, v15
    v_cos_f32 v66, v25
    v_sin_f32 v67, -v25
    v_mul_f32 v25, 4.0, v15
    v_cos_f32 v68, v25
    v_sin_f32 v69, -v25
    v_mul_f32 v25, 5.0, v15
    v_cos_f32 v70, v25
    v_sin_f32 v71, -v25
    v_mul_f32 v25, 6.0, v15
    v_cos_f32 v72, v25
    v_sin_f32 v73, -v25
    v_mul_f32 v25, 7.0, v15
    v_cos_f32 v74, v25
    v_sin_f32 v75, -v25
    s_nop 0
    v_mul_f32 v25, 1.0, v24
    v_cos_f32 v76, v25
    v_sin_f32 v77, -v25
    v_mul_f32 v25, 2.0, v24
    v_cos_f32 v78, v25
    v_sin_f32 v79, -v25
    v_mul_f32 v25, 3.0, v24
    v_cos_f32 v80, v25
    v_sin_f32 v81, -v25
    v_mul_f32 v25, 4.0, v24
    v_cos_f32 v82, v25
    v_sin_f32 v83, -v25
    v_mul_f32 v25, 5.0, v24
    v_cos_f32 v84, v25
    v_sin_f32 v85, -v25
    v_mul_f32 v25, 6.0, v24
    v_cos_f32 v86, v25
    v_sin_f32 v87, -v25
    v_mul_f32 v25, 7.0, v24
    v_cos_f32 v88, v25
    v_sin_f32 v89, -v25
    s_nop 0
    s_waitcnt vmcnt(8)
    v_pk_add_f32 v[90:91], v[32:33], v[40:41]
    v_pk_add_f32 v[92:93], v[34:35], v[42:43]
    v_pk_add_f32 v[94:95], v[36:37], v[44:45]
    v_pk_add_f32 v[96:97], v[38:39], v[46:47]
    v_pk_add_f32 v[98:99], v[32:33], v[40:41] neg_lo:[0,1] neg_hi:[0,1]
    v_pk_add_f32 v[100:101], v[34:35], v[42:43] neg_lo:[0,1] neg_hi:[0,1]
    v_pk_add_f32 v[102:103], v[36:37], v[44:45] neg_lo:[0,1] neg_hi:[0,1]
    v_pk_add_f32 v[104:105], v[38:39], v[46:47] neg_lo:[0,1] neg_hi:[0,1]
    v_pk_add_f32 v[32:33], v[100:101], v[100:101] op_sel:[0,1] op_sel_hi:[1,0] neg_hi:[0,1]
    v_pk_mul_f32 v[32:33], v[32:33], s[20:21]
    v_pk_add_f32 v[34:35], v[104:105], v[104:105] op_sel:[1,0] op_sel_hi:[0,1] neg_lo:[0,1] neg_hi:[1,1]
    v_pk_mul_f32 v[34:35], v[34:35], s[20:21]
    v_pk_add_f32 v[36:37], v[90:91], v[94:95]
    v_pk_add_f32 v[38:39], v[92:93], v[96:97]
    v_pk_add_f32 v[40:41], v[90:91], v[94:95] neg_lo:[0,1] neg_hi:[0,1]
    v_pk_add_f32 v[42:43], v[92:93], v[96:97] neg_lo:[0,1] neg_hi:[0,1]
    v_pk_add_f32 v[44:45], v[36:37], v[38:39]
    v_pk_add_f32 v[46:47], v[36:37], v[38:39] neg_lo:[0,1] neg_hi:[0,1]
    v_pk_add_f32 v[90:91], v[40:41], v[42:43] op_sel:[0,1] op_sel_hi:[1,0] neg_hi:[0,1]
    v_pk_add_f32 v[92:93], v[40:41], v[42:43] op_sel:[0,1] op_sel_hi:[1,0] neg_lo:[0,1]
    v_pk_add_f32 v[36:37], v[98:99], v[102:103] op_sel:[0,1] op_sel_hi:[1,0] neg_hi:[0,1]
    v_pk_add_f32 v[38:39], v[98:99], v[102:103] op_sel:[0,1] op_sel_hi:[1,0] neg_lo:[0,1]
    v_pk_add_f32 v[40:41], v[32:33], v[34:35]
    v_pk_add_f32 v[42:43], v[32:33], v[34:35] neg_lo:[0,1] neg_hi:[0,1]
    v_pk_add_f32 v[32:33], v[36:37], v[40:41]
    v_pk_add_f32 v[34:35], v[36:37], v[40:41] neg_lo:[0,1] neg_hi:[0,1]
    v_pk_add_f32 v[94:95], v[38:39], v[42:43] op_sel:[0,1] op_sel_hi:[1,0] neg_hi:[0,1]
    v_pk_add_f32 v[96:97], v[38:39], v[42:43] op_sel:[0,1] op_sel_hi:[1,0] neg_lo:[0,1]
    v_pk_mul_f32 v[36:37], v[32:33], v[48:49] op_sel:[0,0] op_sel_hi:[0,1]
    v_pk_fma_f32 v[36:37], v[32:33], v[48:49], v[36:37] op_sel:[1,1,0] op_sel_hi:[1,0,1] neg_lo:[1,0,0]
    v_pk_mul_f32 v[32:33], v[90:91], v[50:51] op_sel:[0,0] op_sel_hi:[0,1]
    v_pk_fma_f32 v[32:33], v[90:91], v[50:51], v[32:33] op_sel:[1,1,0] op_sel_hi:[1,0,1] neg_lo:[1,0,0]
    v_pk_mul_f32 v[38:39], v[94:95], v[52:53] op_sel:[0,0] op_sel_hi:[0,1]
    v_pk_fma_f32 v[38:39], v[94:95], v[52:53], v[38:39] op_sel:[1,1,0] op_sel_hi:[1,0,1] neg_lo:[1,0,0]
    v_pk_mul_f32 v[40:41], v[46:47], v[54:55] op_sel:[0,0] op_sel_hi:[0,1]
    v_pk_fma_f32 v[40:41], v[46:47], v[54:55], v[40:41] op_sel:[1,1,0] op_sel_hi:[1,0,1] neg_lo:[1,0,0]
    v_pk_mul_f32 v[42:43], v[34:35], v[56:57] op_sel:[0,0] op_sel_hi:[0,1]
    v_pk_fma_f32 v[42:43], v[34:35], v[56:57], v[42:43] op_sel:[1,1,0] op_sel_hi:[1,0,1] neg_lo:[1,0,0]
    v_pk_mul_f32 v[34:35], v[92:93], v[58:59] op_sel:[0,0] op_sel_hi:[0,1]
    v_pk_fma_f32 v[34:35], v[92:93], v[58:59], v[34:35] op_sel:[1,1,0] op_sel_hi:[1,0,1] neg_lo:[1,0,0]
    v_pk_mul_f32 v[46:47], v[96:97], v[60:61] op_sel:[0,0] op_sel_hi:[0,1]
    v_pk_fma_f32 v[46:47], v[96:97], v[60:61], v[46:47] op_sel:[1,1,0] op_sel_hi:[1,0,1] neg_lo:[1,0,0]
    ds_write_b64 v1, v[44:45] offset:0
    ds_write_b64 v1, v[36:37] offset:2048
    ds_write_b64 v1, v[32:33] offset:4096
    ds_write_b64 v1, v[38:39] offset:6144
    ds_write_b64 v1, v[40:41] offset:8192
    ds_write_b64 v1, v[42:43] offset:10240
    ds_write_b64 v1, v[34:35] offset:12288
    ds_write_b64 v1, v[46:47] offset:14336
    s_waitcnt lgkmcnt(0)
    s_barrier
    ds_read_b64 v[32:33], v7 offset:0
    ds_read_b64 v[34:35], v7 offset:256
    ds_read_b64 v[36:37], v7 offset:512
    ds_read_b64 v[38:39], v7 offset:768
    ds_read_b64 v[40:41], v7 offset:1024
    ds_read_b64 v[42:43], v7 offset:1280
    ds_read_b64 v[44:45], v7 offset:1536
    ds_read_b64 v[46:47], v7 offset:1792
    s_waitcnt lgkmcnt(0)
    s_barrier
    v_pk_add_f32 v[90:91], v[32:33], v[40:41]
    v_pk_add_f32 v[92:93], v[34:35], v[42:43]
    v_pk_add_f32 v[94:95], v[36:37], v[44:45]
    v_pk_add_f32 v[96:97], v[38:39], v[46:47]
    v_pk_add_f32 v[98:99], v[32:33], v[40:41] neg_lo:[0,1] neg_hi:[0,1]
    v_pk_add_f32 v[100:101], v[34:35], v[42:43] neg_lo:[0,1] neg_hi:[0,1]
    v_pk_add_f32 v[102:103], v[36:37], v[44:45] neg_lo:[0,1] neg_hi:[0,1]
    v_pk_add_f32 v[104:105], v[38:39], v[46:47] neg_lo:[0,1] neg_hi:[0,1]
    v_pk_add_f32 v[32:33], v[100:101], v[100:101] op_sel:[0,1] op_sel_hi:[1,0] neg_hi:[0,1]
    v_pk_mul_f32 v[32:33], v[32:33], s[20:21]
    v_pk_add_f32 v[34:35], v[104:105], v[104:105] op_sel:[1,0] op_sel_hi:[0,1] neg_lo:[0,1] neg_hi:[1,1]
    v_pk_mul_f32 v[34:35], v[34:35], s[20:21]
    v_pk_add_f32 v[36:37], v[90:91], v[94:95]
    v_pk_add_f32 v[38:39], v[92:93], v[96:97]
    v_pk_add_f32 v[40:41], v[90:91], v[94:95] neg_lo:[0,1] neg_hi:[0,1]
    v_pk_add_f32 v[42:43], v[92:93], v[96:97] neg_lo:[0,1] neg_hi:[0,1]
    v_pk_add_f32 v[44:45], v[36:37], v[38:39]
    v_pk_add_f32 v[46:47], v[36:37], v[38:39] neg_lo:[0,1] neg_hi:[0,1]
    v_pk_add_f32 v[90:91], v[40:41], v[42:43] op_sel:[0,1] op_sel_hi:[1,0] neg_hi:[0,1]
    v_pk_add_f32 v[92:93], v[40:41], v[42:43] op_sel:[0,1] op_sel_hi:[1,0] neg_lo:[0,1]
    v_pk_add_f32 v[36:37], v[98:99], v[102:103] op_sel:[0,1] op_sel_hi:[1,0] neg_hi:[0,1]
    v_pk_add_f32 v[38:39], v[98:99], v[102:103] op_sel:[0,1] op_sel_hi:[1,0] neg_lo:[0,1]
    v_pk_add_f32 v[40:41], v[32:33], v[34:35]
    v_pk_add_f32 v[42:43], v[32:33], v[34:35] neg_lo:[0,1] neg_hi:[0,1]
    v_pk_add_f32 v[32:33], v[36:37], v[40:41]
    v_pk_add_f32 v[34:35], v[36:37], v[40:41] neg_lo:[0,1] neg_hi:[0,1]
    v_pk_add_f32 v[94:95], v[38:39], v[42:43] op_sel:[0,1] op_sel_hi:[1,0] neg_hi:[0,1]
    v_pk_add_f32 v[96:97], v[38:39], v[42:43] op_sel:[0,1] op_sel_hi:[1,0] neg_lo:[0,1]
    v_pk_mul_f32 v[36:37], v[32:33], v[62:63] op_sel:[0,0] op_sel_hi:[0,1]
    v_pk_fma_f32 v[36:37], v[32:33], v[62:63], v[36:37] op_sel:[1,1,0] op_sel_hi:[1,0,1] neg_lo:[1,0,0]
    v_pk_mul_f32 v[32:33], v[90:91], v[64:65] op_sel:[0,0] op_sel_hi:[0,1]
    v_pk_fma_f32 v[32:33], v[90:91], v[64:65], v[32:33] op_sel:[1,1,0] op_sel_hi:[1,0,1] neg_lo:[1,0,0]
    v_pk_mul_f32 v[38:39], v[94:95], v[66:67] op_sel:[0,0] op_sel_hi:[0,1]
    v_pk_fma_f32 v[38:39], v[94:95], v[66:67], v[38:39] op_sel:[1,1,0] op_sel_hi:[1,0,1] neg_lo:[1,0,0]
    v_pk_mul_f32 v[40:41], v[46:47], v[68:69] op_sel:[0,0] op_sel_hi:[0,1]
    v_pk_fma_f32 v[40:41], v[46:47], v[68:69], v[40:41] op_sel:[1,1,0] op_sel_hi:[1,0,1] neg_lo:[1,0,0]
    v_pk_mul_f32 v[42:43], v[34:35], v[70:71] op_sel:[0,0] op_sel_hi:[0,1]
    v_pk_fma_f32 v[42:43], v[34:35], v[70:71], v[42:43] op_sel:[1,1,0] op_sel_hi:[1,0,1] neg_lo:[1,0,0]
    v_pk_mul_f32 v[34:35], v[92:93], v[72:73] op_sel:[0,0] op_sel_hi:[0,1]
    v_pk_fma_f32 v[34:35], v[92:93], v[72:73], v[34:35] op_sel:[1,1,0] op_sel_hi:[1,0,1] neg_lo:[1,0,0]
    v_pk_mul_f32 v[46:47], v[96:97], v[74:75] op_sel:[0,0] op_sel_hi:[0,1]
    v_pk_fma_f32 v[46:47], v[96:97], v[74:75], v[46:47] op_sel:[1,1,0] op_sel_hi:[1,0,1] neg_lo:[1,0,0]
    ds_write_b64 v8, v[44:45] offset:0
    ds_write_b64 v8, v[36:37] offset:288
    ds_write_b64 v8, v[32:33] offset:576
    ds_write_b64 v8, v[38:39] offset:864
    ds_write_b64 v8, v[40:41] offset:1152
    ds_write_b64 v8, v[42:43] offset:1440
    ds_write_b64 v8, v[34:35] offset:1728
    ds_write_b64 v8, v[46:47] offset:2016
    s_waitcnt lgkmcnt(0)
    s_barrier
    ds_read_b64 v[32:33], v10 offset:0
    ds_read_b64 v[34:35], v10 offset:32
    ds_read_b64 v[36:37], v10 offset:64
    ds_read_b64 v[38:39], v10 offset:96
    ds_read_b64 v[40:41], v10 offset:128
    ds_read_b64 v[42:43], v10 offset:160
    ds_read_b64 v[44:45], v10 offset:192
    ds_read_b64 v[46:47], v10 offset:224
    s_waitcnt lgkmcnt(0)
    s_barrier
    v_pk_add_f32 v[90:91], v[32:33], v[40:41]
    v_pk_add_f32 v[92:93], v[34:35], v[42:43]
    v_pk_add_f32 v[94:95], v[36:37], v[44:45]
    v_pk_add_f32 v[96:97], v[38:39], v[46:47]
    v_pk_add_f32 v[98:99], v[32:33], v[40:41] neg_lo:[0,1] neg_hi:[0,1]
    v_pk_add_f32 v[100:101], v[34:35], v[42:43] neg_lo:[0,1] neg_hi:[0,1]
    v_pk_add_f32 v[102:103], v[36:37], v[44:45] neg_lo:[0,1] neg_hi:[0,1]
    v_pk_add_f32 v[104:105], v[38:39], v[46:47] neg_lo:[0,1] neg_hi:[0,1]
    v_pk_add_f32 v[32:33], v[100:101], v[100:101] op_sel:[0,1] op_sel_hi:[1,0] neg_hi:[0,1]
    v_pk_mul_f32 v[32:33], v[32:33], s[20:21]
    v_pk_add_f32 v[34:35], v[104:105], v[104:105] op_sel:[1,0] op_sel_hi:[0,1] neg_lo:[0,1] neg_hi:[1,1]
    v_pk_mul_f32 v[34:35], v[34:35], s[20:21]
    v_pk_add_f32 v[36:37], v[90:91], v[94:95]
    v_pk_add_f32 v[38:39], v[92:93], v[96:97]
    v_pk_add_f32 v[40:41], v[90:91], v[94:95] neg_lo:[0,1] neg_hi:[0,1]
    v_pk_add_f32 v[42:43], v[92:93], v[96:97] neg_lo:[0,1] neg_hi:[0,1]
    v_pk_add_f32 v[44:45], v[36:37], v[38:39]
    v_pk_add_f32 v[46:47], v[36:37], v[38:39] neg_lo:[0,1] neg_hi:[0,1]
    v_pk_add_f32 v[90:91], v[40:41], v[42:43] op_sel:[0,1] op_sel_hi:[1,0] neg_hi:[0,1]
    v_pk_add_f32 v[92:93], v[40:41], v[42:43] op_sel:[0,1] op_sel_hi:[1,0] neg_lo:[0,1]
    v_pk_add_f32 v[36:37], v[98:99], v[102:103] op_sel:[0,1] op_sel_hi:[1,0] neg_hi:[0,1]
    v_pk_add_f32 v[38:39], v[98:99], v[102:103] op_sel:[0,1] op_sel_hi:[1,0] neg_lo:[0,1]
    v_pk_add_f32 v[40:41], v[32:33], v[34:35]
    v_pk_add_f32 v[42:43], v[32:33], v[34:35] neg_lo:[0,1] neg_hi:[0,1]
    v_pk_add_f32 v[32:33], v[36:37], v[40:41]
    v_pk_add_f32 v[34:35], v[36:37], v[40:41] neg_lo:[0,1] neg_hi:[0,1]
    v_pk_add_f32 v[94:95], v[38:39], v[42:43] op_sel:[0,1] op_sel_hi:[1,0] neg_hi:[0,1]
    v_pk_add_f32 v[96:97], v[38:39], v[42:43] op_sel:[0,1] op_sel_hi:[1,0] neg_lo:[0,1]
    v_pk_mul_f32 v[36:37], v[32:33], v[76:77] op_sel:[0,0] op_sel_hi:[0,1]
    v_pk_fma_f32 v[36:37], v[32:33], v[76:77], v[36:37] op_sel:[1,1,0] op_sel_hi:[1,0,1] neg_lo:[1,0,0]
    v_pk_mul_f32 v[32:33], v[90:91], v[78:79] op_sel:[0,0] op_sel_hi:[0,1]
    v_pk_fma_f32 v[32:33], v[90:91], v[78:79], v[32:33] op_sel:[1,1,0] op_sel_hi:[1,0,1] neg_lo:[1,0,0]
    v_pk_mul_f32 v[38:39], v[94:95], v[80:81] op_sel:[0,0] op_sel_hi:[0,1]
    v_pk_fma_f32 v[38:39], v[94:95], v[80:81], v[38:39] op_sel:[1,1,0] op_sel_hi:[1,0,1] neg_lo:[1,0,0]
    v_pk_mul_f32 v[40:41], v[46:47], v[82:83] op_sel:[0,0] op_sel_hi:[0,1]
    v_pk_fma_f32 v[40:41], v[46:47], v[82:83], v[40:41] op_sel:[1,1,0] op_sel_hi:[1,0,1] neg_lo:[1,0,0]
    v_pk_mul_f32 v[42:43], v[34:35], v[84:85] op_sel:[0,0] op_sel_hi:[0,1]
    v_pk_fma_f32 v[42:43], v[34:35], v[84:85], v[42:43] op_sel:[1,1,0] op_sel_hi:[1,0,1] neg_lo:[1,0,0]
    v_pk_mul_f32 v[34:35], v[92:93], v[86:87] op_sel:[0,0] op_sel_hi:[0,1]
    v_pk_fma_f32 v[34:35], v[92:93], v[86:87], v[34:35] op_sel:[1,1,0] op_sel_hi:[1,0,1] neg_lo:[1,0,0]
    v_pk_mul_f32 v[46:47], v[96:97], v[88:89] op_sel:[0,0] op_sel_hi:[0,1]
    v_pk_fma_f32 v[46:47], v[96:97], v[88:89], v[46:47] op_sel:[1,1,0] op_sel_hi:[1,0,1] neg_lo:[1,0,0]
    ds_write_b64 v12, v[44:45] offset:0
    ds_write_b64 v12, v[36:37] offset:2304
    ds_write_b64 v12, v[32:33] offset:4608
    ds_write_b64 v12, v[38:39] offset:6912
    ds_write_b64 v12, v[40:41] offset:9216
    ds_write_b64 v12, v[42:43] offset:11520
    ds_write_b64 v12, v[34:35] offset:13824
    ds_write_b64 v12, v[46:47] offset:16128
    s_waitcnt lgkmcnt(0)
    s_barrier
    ds_read_b64 v[32:33], v13 offset:0
    ds_read_b64 v[34:35], v13 offset:576
    ds_read_b64 v[36:37], v13 offset:1152
    ds_read_b64 v[38:39], v13 offset:1728
    ds_read_b64 v[40:41], v13 offset:2304
    ds_read_b64 v[42:43], v13 offset:2880
    ds_read_b64 v[44:45], v13 offset:3456
    ds_read_b64 v[46:47], v13 offset:4032
    s_waitcnt lgkmcnt(0)
    s_barrier
    v_pk_add_f32 v[90:91], v[32:33], v[36:37]
    v_pk_add_f32 v[92:93], v[34:35], v[38:39]
    v_pk_add_f32 v[94:95], v[32:33], v[36:37] neg_lo:[0,1] neg_hi:[0,1]
    v_pk_add_f32 v[96:97], v[34:35], v[38:39] neg_lo:[0,1] neg_hi:[0,1]
    v_pk_add_f32 v[32:33], v[90:91], v[92:93]
    v_pk_add_f32 v[34:35], v[90:91], v[92:93] neg_lo:[0,1] neg_hi:[0,1]
    v_pk_add_f32 v[36:37], v[94:95], v[96:97] op_sel:[0,1] op_sel_hi:[1,0] neg_hi:[0,1]
    v_pk_add_f32 v[38:39], v[94:95], v[96:97] op_sel:[0,1] op_sel_hi:[1,0] neg_lo:[0,1]
    v_pk_add_f32 v[90:91], v[40:41], v[44:45]
    v_pk_add_f32 v[92:93], v[42:43], v[46:47]
    v_pk_add_f32 v[94:95], v[40:41], v[44:45] neg_lo:[0,1] neg_hi:[0,1]
    v_pk_add_f32 v[96:97], v[42:43], v[46:47] neg_lo:[0,1] neg_hi:[0,1]
    v_pk_add_f32 v[40:41], v[90:91], v[92:93]
    v_pk_add_f32 v[42:43], v[90:91], v[92:93] neg_lo:[0,1] neg_hi:[0,1]
    v_pk_add_f32 v[44:45], v[94:95], v[96:97] op_sel:[0,1] op_sel_hi:[1,0] neg_hi:[0,1]
    v_pk_add_f32 v[46:47], v[94:95], v[96:97] op_sel:[0,1] op_sel_hi:[1,0] neg_lo:[0,1]
    s_waitcnt vmcnt(0)
    v_lshlrev_b32 v90, 16, v16
    v_and_b32 v91, 0xffff0000, v16
    v_pk_mul_f32 v[92:93], v[32:33], v[90:91] op_sel:[0,0] op_sel_hi:[0,1]
    v_pk_fma_f32 v[92:93], v[32:33], v[90:91], v[92:93] op_sel:[1,1,0] op_sel_hi:[1,0,1] neg_lo:[1,0,0]
    v_lshlrev_b32 v32, 16, v17
    v_and_b32 v33, 0xffff0000, v17
    v_pk_mul_f32 v[90:91], v[36:37], v[32:33] op_sel:[0,0] op_sel_hi:[0,1]
    v_pk_fma_f32 v[90:91], v[36:37], v[32:33], v[90:91] op_sel:[1,1,0] op_sel_hi:[1,0,1] neg_lo:[1,0,0]
    v_lshlrev_b32 v32, 16, v18
    v_and_b32 v33, 0xffff0000, v18
    v_pk_mul_f32 v[36:37], v[34:35], v[32:33] op_sel:[0,0] op_sel_hi:[0,1]
    v_pk_fma_f32 v[36:37], v[34:35], v[32:33], v[36:37] op_sel:[1,1,0] op_sel_hi:[1,0,1] neg_lo:[1,0,0]
    v_lshlrev_b32 v32, 16, v19
    v_and_b32 v33, 0xffff0000, v19
    v_pk_mul_f32 v[34:35], v[38:39], v[32:33] op_sel:[0,0] op_sel_hi:[0,1]
    v_pk_fma_f32 v[34:35], v[38:39], v[32:33], v[34:35] op_sel:[1,1,0] op_sel_hi:[1,0,1] neg_lo:[1,0,0]
    v_lshlrev_b32 v32, 16, v20
    v_and_b32 v33, 0xffff0000, v20
    v_pk_mul_f32 v[38:39], v[40:41], v[32:33] op_sel:[0,0] op_sel_hi:[0,1]
    v_pk_fma_f32 v[38:39], v[40:41], v[32:33], v[38:39] op_sel:[1,1,0] op_sel_hi:[1,0,1] neg_lo:[1,0,0]
    v_lshlrev_b32 v32, 16, v21
    v_and_b32 v33, 0xffff0000, v21
    v_pk_mul_f32 v[40:41], v[44:45], v[32:33] op_sel:[0,0] op_sel_hi:[0,1]
    v_pk_fma_f32 v[40:41], v[44:45], v[32:33], v[40:41] op_sel:[1,1,0] op_sel_hi:[1,0,1] neg_lo:[1,0,0]
    v_lshlrev_b32 v32, 16, v22
    v_and_b32 v33, 0xffff0000, v22
    v_pk_mul_f32 v[44:45], v[42:43], v[32:33] op_sel:[0,0] op_sel_hi:[0,1]
    v_pk_fma_f32 v[44:45], v[42:43], v[32:33], v[44:45] op_sel:[1,1,0] op_sel_hi:[1,0,1] neg_lo:[1,0,0]
    v_lshlrev_b32 v32, 16, v23
    v_and_b32 v33, 0xffff0000, v23
    v_pk_mul_f32 v[42:43], v[46:47], v[32:33] op_sel:[0,0] op_sel_hi:[0,1]
    v_pk_fma_f32 v[42:43], v[46:47], v[32:33], v[42:43] op_sel:[1,1,0] op_sel_hi:[1,0,1] neg_lo:[1,0,0]
    v_pk_add_f32 v[32:33], v[92:93], v[36:37]
    v_pk_add_f32 v[46:47], v[90:91], v[34:35]
    v_pk_add_f32 v[94:95], v[92:93], v[36:37] neg_lo:[0,1] neg_hi:[0,1]
    v_pk_add_f32 v[96:97], v[90:91], v[34:35] neg_lo:[0,1] neg_hi:[0,1]
    v_pk_add_f32 v[34:35], v[32:33], v[46:47]
    v_pk_add_f32 v[36:37], v[32:33], v[46:47] neg_lo:[0,1] neg_hi:[0,1]
    v_pk_add_f32 v[90:91], v[94:95], v[96:97] op_sel:[0,1] op_sel_hi:[1,0] neg_lo:[0,1]
    v_pk_add_f32 v[92:93], v[94:95], v[96:97] op_sel:[0,1] op_sel_hi:[1,0] neg_hi:[0,1]
    v_pk_add_f32 v[32:33], v[38:39], v[44:45]
    v_pk_add_f32 v[46:47], v[40:41], v[42:43]
    v_pk_add_f32 v[94:95], v[38:39], v[44:45] neg_lo:[0,1] neg_hi:[0,1]
    v_pk_add_f32 v[96:97], v[40:41], v[42:43] neg_lo:[0,1] neg_hi:[0,1]
    v_pk_add_f32 v[38:39], v[32:33], v[46:47]
    v_pk_add_f32 v[40:41], v[32:33], v[46:47] neg_lo:[0,1] neg_hi:[0,1]
    v_pk_add_f32 v[42:43], v[94:95], v[96:97] op_sel:[0,1] op_sel_hi:[1,0] neg_lo:[0,1]
    v_pk_add_f32 v[44:45], v[94:95], v[96:97] op_sel:[0,1] op_sel_hi:[1,0] neg_hi:[0,1]
    ds_write_b64 v13, v[34:35] offset:0
    ds_write_b64 v13, v[90:91] offset:576
    ds_write_b64 v13, v[36:37] offset:1152
    ds_write_b64 v13, v[92:93] offset:1728
    ds_write_b64 v13, v[38:39] offset:2304
    ds_write_b64 v13, v[42:43] offset:2880
    ds_write_b64 v13, v[40:41] offset:3456
    ds_write_b64 v13, v[44:45] offset:4032
    s_waitcnt lgkmcnt(0)
    s_barrier
    ds_read_b64 v[32:33], v12 offset:0
    ds_read_b64 v[34:35], v12 offset:2304
    ds_read_b64 v[36:37], v12 offset:4608
    ds_read_b64 v[38:39], v12 offset:6912
    ds_read_b64 v[40:41], v12 offset:9216
    ds_read_b64 v[42:43], v12 offset:11520
    ds_read_b64 v[44:45], v12 offset:13824
    ds_read_b64 v[46:47], v12 offset:16128
    s_waitcnt lgkmcnt(0)
    s_barrier
    v_pk_mul_f32 v[90:91], v[34:35], v[76:77] op_sel:[0,0] op_sel_hi:[0,1] neg_hi:[0,1]
    v_pk_fma_f32 v[90:91], v[34:35], v[76:77], v[90:91] op_sel:[1,1,0] op_sel_hi:[1,0,1]
    v_pk_mul_f32 v[34:35], v[36:37], v[78:79] op_sel:[0,0] op_sel_hi:[0,1] neg_hi:[0,1]
    v_pk_fma_f32 v[34:35], v[36:37], v[78:79], v[34:35] op_sel:[1,1,0] op_sel_hi:[1,0,1]
    v_pk_mul_f32 v[36:37], v[38:39], v[80:81] op_sel:[0,0] op_sel_hi:[0,1] neg_hi:[0,1]
    v_pk_fma_f32 v[36:37], v[38:39], v[80:81], v[36:37] op_sel:[1,1,0] op_sel_hi:[1,0,1]
    v_pk_mul_f32 v[38:39], v[40:41], v[82:83] op_sel:[0,0] op_sel_hi:[0,1] neg_hi:[0,1]
    v_pk_fma_f32 v[38:39], v[40:41], v[82:83], v[38:39] op_sel:[1,1,0] op_sel_hi:[1,0,1]
    v_pk_mul_f32 v[40:41], v[42:43], v[84:85] op_sel:[0,0] op_sel_hi:[0,1] neg_hi:[0,1]
    v_pk_fma_f32 v[40:41], v[42:43], v[84:85], v[40:41] op_sel:[1,1,0] op_sel_hi:[1,0,1]
    v_pk_mul_f32 v[42:43], v[44:45], v[86:87] op_sel:[0,0] op_sel_hi:[0,1] neg_hi:[0,1]
    v_pk_fma_f32 v[42:43], v[44:45], v[86:87], v[42:43] op_sel:[1,1,0] op_sel_hi:[1,0,1]
    v_pk_mul_f32 v[44:45], v[46:47], v[88:89] op_sel:[0,0] op_sel_hi:[0,1] neg_hi:[0,1]
    v_pk_fma_f32 v[44:45], v[46:47], v[88:89], v[44:45] op_sel:[1,1,0] op_sel_hi:[1,0,1]
    v_pk_add_f32 v[46:47], v[32:33], v[38:39]
    v_pk_add_f32 v[92:93], v[90:91], v[40:41]
    v_pk_add_f32 v[94:95], v[34:35], v[42:43]
    v_pk_add_f32 v[96:97], v[36:37], v[44:45]
    v_pk_add_f32 v[98:99], v[32:33], v[38:39] neg_lo:[0,1] neg_hi:[0,1]
    v_pk_add_f32 v[100:101], v[90:91], v[40:41] neg_lo:[0,1] neg_hi:[0,1]
    v_pk_add_f32 v[102:103], v[34:35], v[42:43] neg_lo:[0,1] neg_hi:[0,1]
    v_pk_add_f32 v[104:105], v[36:37], v[44:45] neg_lo:[0,1] neg_hi:[0,1]
    v_pk_add_f32 v[32:33], v[100:101], v[100:101] op_sel:[0,1] op_sel_hi:[1,0] neg_lo:[0,1]
    v_pk_mul_f32 v[32:33], v[32:33], s[20:21]
    v_pk_add_f32 v[34:35], v[104:105], v[104:105] op_sel:[0,1] op_sel_hi:[0,1] neg_lo:[1,1] neg_hi:[0,1]
    v_pk_mul_f32 v[34:35], v[34:35], s[20:21]
    v_pk_add_f32 v[36:37], v[46:47], v[94:95]
    v_pk_add_f32 v[38:39], v[92:93], v[96:97]
    v_pk_add_f32 v[40:41], v[46:47], v[94:95] neg_lo:[0,1] neg_hi:[0,1]
    v_pk_add_f32 v[42:43], v[92:93], v[96:97] neg_lo:[0,1] neg_hi:[0,1]
    v_pk_add_f32 v[44:45], v[36:37], v[38:39]
    v_pk_add_f32 v[46:47], v[36:37], v[38:39] neg_lo:[0,1] neg_hi:[0,1]
    v_pk_add_f32 v[90:91], v[40:41], v[42:43] op_sel:[0,1] op_sel_hi:[1,0] neg_lo:[0,1]
    v_pk_add_f32 v[92:93], v[40:41], v[42:43] op_sel:[0,1] op_sel_hi:[1,0] neg_hi:[0,1]
    v_pk_add_f32 v[36:37], v[98:99], v[102:103] op_sel:[0,1] op_sel_hi:[1,0] neg_lo:[0,1]
    v_pk_add_f32 v[38:39], v[98:99], v[102:103] op_sel:[0,1] op_sel_hi:[1,0] neg_hi:[0,1]
    v_pk_add_f32 v[40:41], v[32:33], v[34:35]
    v_pk_add_f32 v[42:43], v[32:33], v[34:35] neg_lo:[0,1] neg_hi:[0,1]
    v_pk_add_f32 v[32:33], v[36:37], v[40:41]
    v_pk_add_f32 v[34:35], v[36:37], v[40:41] neg_lo:[0,1] neg_hi:[0,1]
    v_pk_add_f32 v[94:95], v[38:39], v[42:43] op_sel:[0,1] op_sel_hi:[1,0] neg_lo:[0,1]
    v_pk_add_f32 v[96:97], v[38:39], v[42:43] op_sel:[0,1] op_sel_hi:[1,0] neg_hi:[0,1]
    ds_write_b64 v10, v[44:45] offset:0
    ds_write_b64 v10, v[32:33] offset:32
    ds_write_b64 v10, v[90:91] offset:64
    ds_write_b64 v10, v[94:95] offset:96
    ds_write_b64 v10, v[46:47] offset:128
    ds_write_b64 v10, v[34:35] offset:160
    ds_write_b64 v10, v[92:93] offset:192
    ds_write_b64 v10, v[96:97] offset:224
    s_waitcnt lgkmcnt(0)
    s_barrier
    ds_read_b64 v[32:33], v8 offset:0
    ds_read_b64 v[34:35], v8 offset:288
    ds_read_b64 v[36:37], v8 offset:576
    ds_read_b64 v[38:39], v8 offset:864
    ds_read_b64 v[40:41], v8 offset:1152
    ds_read_b64 v[42:43], v8 offset:1440
    ds_read_b64 v[44:45], v8 offset:1728
    ds_read_b64 v[46:47], v8 offset:2016
    s_waitcnt lgkmcnt(0)
    s_barrier
    v_pk_mul_f32 v[90:91], v[34:35], v[62:63] op_sel:[0,0] op_sel_hi:[0,1] neg_hi:[0,1]
    v_pk_fma_f32 v[90:91], v[34:35], v[62:63], v[90:91] op_sel:[1,1,0] op_sel_hi:[1,0,1]
    v_pk_mul_f32 v[34:35], v[36:37], v[64:65] op_sel:[0,0] op_sel_hi:[0,1] neg_hi:[0,1]
    v_pk_fma_f32 v[34:35], v[36:37], v[64:65], v[34:35] op_sel:[1,1,0] op_sel_hi:[1,0,1]
    v_pk_mul_f32 v[36:37], v[38:39], v[66:67] op_sel:[0,0] op_sel_hi:[0,1] neg_hi:[0,1]
    v_pk_fma_f32 v[36:37], v[38:39], v[66:67], v[36:37] op_sel:[1,1,0] op_sel_hi:[1,0,1]
    v_pk_mul_f32 v[38:39], v[40:41], v[68:69] op_sel:[0,0] op_sel_hi:[0,1] neg_hi:[0,1]
    v_pk_fma_f32 v[38:39], v[40:41], v[68:69], v[38:39] op_sel:[1,1,0] op_sel_hi:[1,0,1]
    v_pk_mul_f32 v[40:41], v[42:43], v[70:71] op_sel:[0,0] op_sel_hi:[0,1] neg_hi:[0,1]
    v_pk_fma_f32 v[40:41], v[42:43], v[70:71], v[40:41] op_sel:[1,1,0] op_sel_hi:[1,0,1]
    v_pk_mul_f32 v[42:43], v[44:45], v[72:73] op_sel:[0,0] op_sel_hi:[0,1] neg_hi:[0,1]
    v_pk_fma_f32 v[42:43], v[44:45], v[72:73], v[42:43] op_sel:[1,1,0] op_sel_hi:[1,0,1]
    v_pk_mul_f32 v[44:45], v[46:47], v[74:75] op_sel:[0,0] op_sel_hi:[0,1] neg_hi:[0,1]
    v_pk_fma_f32 v[44:45], v[46:47], v[74:75], v[44:45] op_sel:[1,1,0] op_sel_hi:[1,0,1]
    v_pk_add_f32 v[46:47], v[32:33], v[38:39]
    v_pk_add_f32 v[92:93], v[90:91], v[40:41]
    v_pk_add_f32 v[94:95], v[34:35], v[42:43]
    v_pk_add_f32 v[96:97], v[36:37], v[44:45]
    v_pk_add_f32 v[98:99], v[32:33], v[38:39] neg_lo:[0,1] neg_hi:[0,1]
    v_pk_add_f32 v[100:101], v[90:91], v[40:41] neg_lo:[0,1] neg_hi:[0,1]
    v_pk_add_f32 v[102:103], v[34:35], v[42:43] neg_lo:[0,1] neg_hi:[0,1]
    v_pk_add_f32 v[104:105], v[36:37], v[44:45] neg_lo:[0,1] neg_hi:[0,1]
    v_pk_add_f32 v[32:33], v[100:101], v[100:101] op_sel:[0,1] op_sel_hi:[1,0] neg_lo:[0,1]
    v_pk_mul_f32 v[32:33], v[32:33], s[20:21]
    v_pk_add_f32 v[34:35], v[104:105], v[104:105] op_sel:[0,1] op_sel_hi:[0,1] neg_lo:[1,1] neg_hi:[0,1]
    v_pk_mul_f32 v[34:35], v[34:35], s[20:21]
    v_pk_add_f32 v[36:37], v[46:47], v[94:95]
    v_pk_add_f32 v[38:39], v[92:93], v[96:97]
    v_pk_add_f32 v[40:41], v[46:47], v[94:95] neg_lo:[0,1] neg_hi:[0,1]
    v_pk_add_f32 v[42:43], v[92:93], v[96:97] neg_lo:[0,1] neg_hi:[0,1]
    v_pk_add_f32 v[44:45], v[36:37], v[38:39]
    v_pk_add_f32 v[46:47], v[36:37], v[38:39] neg_lo:[0,1] neg_hi:[0,1]
    v_pk_add_f32 v[90:91], v[40:41], v[42:43] op_sel:[0,1] op_sel_hi:[1,0] neg_lo:[0,1]
    v_pk_add_f32 v[92:93], v[40:41], v[42:43] op_sel:[0,1] op_sel_hi:[1,0] neg_hi:[0,1]
    v_pk_add_f32 v[36:37], v[98:99], v[102:103] op_sel:[0,1] op_sel_hi:[1,0] neg_lo:[0,1]
    v_pk_add_f32 v[38:39], v[98:99], v[102:103] op_sel:[0,1] op_sel_hi:[1,0] neg_hi:[0,1]
    v_pk_add_f32 v[40:41], v[32:33], v[34:35]
    v_pk_add_f32 v[42:43], v[32:33], v[34:35] neg_lo:[0,1] neg_hi:[0,1]
    v_pk_add_f32 v[32:33], v[36:37], v[40:41]
    v_pk_add_f32 v[34:35], v[36:37], v[40:41] neg_lo:[0,1] neg_hi:[0,1]
    v_pk_add_f32 v[94:95], v[38:39], v[42:43] op_sel:[0,1] op_sel_hi:[1,0] neg_lo:[0,1]
    v_pk_add_f32 v[96:97], v[38:39], v[42:43] op_sel:[0,1] op_sel_hi:[1,0] neg_hi:[0,1]
    ds_write_b64 v7, v[44:45] offset:0
    ds_write_b64 v7, v[32:33] offset:256
    ds_write_b64 v7, v[90:91] offset:512
    ds_write_b64 v7, v[94:95] offset:768
    ds_write_b64 v7, v[46:47] offset:1024
    ds_write_b64 v7, v[34:35] offset:1280
    ds_write_b64 v7, v[92:93] offset:1536
    ds_write_b64 v7, v[96:97] offset:1792
    s_waitcnt lgkmcnt(0)
    s_barrier
    ds_read_b64 v[32:33], v1 offset:0
    ds_read_b64 v[34:35], v1 offset:2048
    ds_read_b64 v[36:37], v1 offset:4096
    ds_read_b64 v[38:39], v1 offset:6144
    ds_read_b64 v[40:41], v1 offset:8192
    ds_read_b64 v[42:43], v1 offset:10240
    ds_read_b64 v[44:45], v1 offset:12288
    ds_read_b64 v[46:47], v1 offset:14336
    s_waitcnt lgkmcnt(0)
    s_barrier
    v_pk_mul_f32 v[90:91], v[34:35], v[48:49] op_sel:[0,0] op_sel_hi:[0,1] neg_hi:[0,1]
    v_pk_fma_f32 v[90:91], v[34:35], v[48:49], v[90:91] op_sel:[1,1,0] op_sel_hi:[1,0,1]
    v_pk_mul_f32 v[34:35], v[36:37], v[50:51] op_sel:[0,0] op_sel_hi:[0,1] neg_hi:[0,1]
    v_pk_fma_f32 v[34:35], v[36:37], v[50:51], v[34:35] op_sel:[1,1,0] op_sel_hi:[1,0,1]
    v_pk_mul_f32 v[36:37], v[38:39], v[52:53] op_sel:[0,0] op_sel_hi:[0,1] neg_hi:[0,1]
    v_pk_fma_f32 v[36:37], v[38:39], v[52:53], v[36:37] op_sel:[1,1,0] op_sel_hi:[1,0,1]
    v_pk_mul_f32 v[38:39], v[40:41], v[54:55] op_sel:[0,0] op_sel_hi:[0,1] neg_hi:[0,1]
    v_pk_fma_f32 v[38:39], v[40:41], v[54:55], v[38:39] op_sel:[1,1,0] op_sel_hi:[1,0,1]
    v_pk_mul_f32 v[40:41], v[42:43], v[56:57] op_sel:[0,0] op_sel_hi:[0,1] neg_hi:[0,1]
    v_pk_fma_f32 v[40:41], v[42:43], v[56:57], v[40:41] op_sel:[1,1,0] op_sel_hi:[1,0,1]
    v_pk_mul_f32 v[42:43], v[44:45], v[58:59] op_sel:[0,0] op_sel_hi:[0,1] neg_hi:[0,1]
    v_pk_fma_f32 v[42:43], v[44:45], v[58:59], v[42:43] op_sel:[1,1,0] op_sel_hi:[1,0,1]
    v_pk_mul_f32 v[44:45], v[46:47], v[60:61] op_sel:[0,0] op_sel_hi:[0,1] neg_hi:[0,1]
    v_pk_fma_f32 v[44:45], v[46:47], v[60:61], v[44:45] op_sel:[1,1,0] op_sel_hi:[1,0,1]
    v_pk_add_f32 v[46:47], v[32:33], v[38:39]
    v_pk_add_f32 v[92:93], v[90:91], v[40:41]
    v_pk_add_f32 v[94:95], v[34:35], v[42:43]
    v_pk_add_f32 v[96:97], v[36:37], v[44:45]
    v_pk_add_f32 v[98:99], v[32:33], v[38:39] neg_lo:[0,1] neg_hi:[0,1]
    v_pk_add_f32 v[100:101], v[90:91], v[40:41] neg_lo:[0,1] neg_hi:[0,1]
    v_pk_add_f32 v[102:103], v[34:35], v[42:43] neg_lo:[0,1] neg_hi:[0,1]
    v_pk_add_f32 v[104:105], v[36:37], v[44:45] neg_lo:[0,1] neg_hi:[0,1]
    v_pk_add_f32 v[32:33], v[100:101], v[100:101] op_sel:[0,1] op_sel_hi:[1,0] neg_lo:[0,1]
    v_pk_mul_f32 v[32:33], v[32:33], s[20:21]
    v_pk_add_f32 v[34:35], v[104:105], v[104:105] op_sel:[0,1] op_sel_hi:[0,1] neg_lo:[1,1] neg_hi:[0,1]
    v_pk_mul_f32 v[34:35], v[34:35], s[20:21]
    v_pk_add_f32 v[36:37], v[46:47], v[94:95]
    v_pk_add_f32 v[38:39], v[92:93], v[96:97]
    v_pk_add_f32 v[40:41], v[46:47], v[94:95] neg_lo:[0,1] neg_hi:[0,1]
    v_pk_add_f32 v[42:43], v[92:93], v[96:97] neg_lo:[0,1] neg_hi:[0,1]
    v_pk_add_f32 v[44:45], v[36:37], v[38:39]
    v_pk_add_f32 v[46:47], v[36:37], v[38:39] neg_lo:[0,1] neg_hi:[0,1]
    v_pk_add_f32 v[90:91], v[40:41], v[42:43] op_sel:[0,1] op_sel_hi:[1,0] neg_lo:[0,1]
    v_pk_add_f32 v[92:93], v[40:41], v[42:43] op_sel:[0,1] op_sel_hi:[1,0] neg_hi:[0,1]
    v_pk_add_f32 v[36:37], v[98:99], v[102:103] op_sel:[0,1] op_sel_hi:[1,0] neg_lo:[0,1]
    v_pk_add_f32 v[38:39], v[98:99], v[102:103] op_sel:[0,1] op_sel_hi:[1,0] neg_hi:[0,1]
    v_pk_add_f32 v[40:41], v[32:33], v[34:35]
    v_pk_add_f32 v[42:43], v[32:33], v[34:35] neg_lo:[0,1] neg_hi:[0,1]
    v_pk_add_f32 v[32:33], v[36:37], v[40:41]
    v_pk_add_f32 v[34:35], v[36:37], v[40:41] neg_lo:[0,1] neg_hi:[0,1]
    v_pk_add_f32 v[94:95], v[38:39], v[42:43] op_sel:[0,1] op_sel_hi:[1,0] neg_lo:[0,1]
    v_pk_add_f32 v[96:97], v[38:39], v[42:43] op_sel:[0,1] op_sel_hi:[1,0] neg_hi:[0,1]
    buffer_store_dwordx2 v[44:45], v1, s[24:27], s3 offen offset:0
    buffer_store_dwordx2 v[32:33], v1, s[24:27], s3 offen offset:2048
    s_add_u32 s99, s3, 4096
    buffer_store_dwordx2 v[90:91], v1, s[24:27], s99 offen offset:0
    s_add_u32 s99, s3, 4096
    buffer_store_dwordx2 v[94:95], v1, s[24:27], s99 offen offset:2048
    s_add_u32 s99, s3, 8192
    buffer_store_dwordx2 v[46:47], v1, s[24:27], s99 offen offset:0
    s_add_u32 s99, s3, 8192
    buffer_store_dwordx2 v[34:35], v1, s[24:27], s99 offen offset:2048
    s_add_u32 s99, s3, 12288
    buffer_store_dwordx2 v[92:93], v1, s[24:27], s99 offen offset:0
    s_add_u32 s99, s3, 12288
    buffer_store_dwordx2 v[96:97], v1, s[24:27], s99 offen offset:2048
k2_kernel_end:
    s_endpgm
.globl k3_kernel
.p2align 8
.type k3_kernel,@function
k3_kernel:
    s_load_dwordx2 s[4:5], s[0:1], 0
    s_load_dwordx2 s[10:11], s[0:1], 72
    s_mov_b32 s20, 0x3f3504f3
    s_mov_b32 s21, 0x3f3504f3
    s_cmp_ge_u32 s2, 256
    s_cbranch_scc1 k3_kernel_end
    s_waitcnt lgkmcnt(0)
    s_mov_b32 s24, s10
    s_and_b32 s25, s11, 0xffff
    s_mov_b32 s26, 20971520
    s_mov_b32 s27, 0x00020000
    s_mov_b32 s28, s4
    s_and_b32 s29, s5, 0xffff
    s_mov_b32 s30, 2097152
    s_mov_b32 s31, 0x00020000
    v_and_b32 v1, 63, v0
    v_lshrrev_b32 v3, 6, v0
    v_mul_u32_u24 v2, 4608, v3
    s_lshl_b32 s3, s2, 6
    v_lshlrev_b32 v30, 4, v3
    v_lshl_add_u32 v30, v1, 14, v30
    v_add_u32 v30, s3, v30
    s_mov_b32 s6, 0
    buffer_load_dwordx4 v[100:103], v30, s[24:27], s6 offen
    s_mov_b32 s6, 1048576
    buffer_load_dwordx4 v[104:107], v30, s[24:27], s6 offen
    s_mov_b32 s6, 2097152
    buffer_load_dwordx4 v[108:111], v30, s[24:27], s6 offen
    s_mov_b32 s6, 3145728
    buffer_load_dwordx4 v[112:115], v30, s[24:27], s6 offen
    v_lshlrev_b32 v31, 4, v3
    v_add_u32 v31, s3, v31
    s_mov_b32 s6, 4194304
    buffer_load_dwordx4 v[116:119], v31, s[24:27], s6 offen
    s_lshl_b32 s7, s2, 13
    v_lshlrev_b32 v26, 11, v3
    v_lshl_add_u32 v26, v1, 4, v26
    v_add_u32 v26, s7, v26
    buffer_load_dwordx4 v[120:123], v26, s[28:31], 0 offen
    buffer_load_dwordx4 v[124:127], v26, s[28:31], 0 offen offset:1024
    v_xor_b32 v4, 1, v1
    v_lshlrev_b32 v4, 2, v4
    v_xor_b32 v5, 2, v1
    v_lshlrev_b32 v5, 2, v5
    v_xor_b32 v6, 4, v1
    v_lshlrev_b32 v6, 2, v6
    v_xor_b32 v7, 8, v1
    v_lshlrev_b32 v7, 2, v7
    v_xor_b32 v8, 16, v1
    v_lshlrev_b32 v8, 2, v8
    v_xor_b32 v9, 32, v1
    v_lshlrev_b32 v9, 2, v9
    v_lshlrev_b32 v20, 3, v1
    v_add_u32 v20, v20, v2
    v_lshrrev_b32 v10, 3, v1
    v_mul_u32_u24 v10, 576, v10
    v_add_u32 v10, v10, v2
    v_and_b32 v11, 7, v1
    v_lshlrev_b32 v12, 3, v11
    v_add_u32 v21, v10, v12
    v_mov_b32 v22, v21
    v_mul_u32_u24 v12, 72, v11
    v_add_u32 v23, v10, v12
    v_cvt_f32_u32 v24, v1
    v_mul_f32 v24, 0x3b000000, v24
    v_cvt_f32_u32 v25, v11
    v_mul_f32 v25, 0x3c800000, v25
    v_sub_u32 v29, 512, v1
    v_lshl_add_u32 v29, v29, 3, v2
    v_subrev_u32 v29, 2048, v29
    s_waitcnt vmcnt(2)
    v_cmp_ne_u32 vcc, 0, v1
    s_nop 1
    v_cndmask_b32 v101, 0, v101, vcc
    v_cndmask_b32 v103, 0, v103, vcc
    v_sub_f32 v32, v100, v103
    v_add_f32 v33, v101, v102
    v_add_f32 v34, v100, v103
    v_sub_f32 v35, v102, v101
    ds_write_b64 v20, v[32:33] offset:0
    s_and_saveexec_b64 s[32:33], vcc
    ds_write_b64 v29, v[34:35] offset:2048
    s_mov_b64 exec, s[32:33]
    s_nop 0
    v_sub_f32 v32, v104, v107
    v_add_f32 v33, v105, v106
    v_add_f32 v34, v104, v107
    v_sub_f32 v35, v106, v105
    ds_write_b64 v20, v[32:33] offset:512
    ds_write_b64 v29, v[34:35] offset:1536
    s_nop 0
    v_sub_f32 v32, v108, v111
    v_add_f32 v33, v109, v110
    v_add_f32 v34, v108, v111
    v_sub_f32 v35, v110, v109
    ds_write_b64 v20, v[32:33] offset:1024
    ds_write_b64 v29, v[34:35] offset:1024
    s_nop 0
    v_sub_f32 v32, v112, v115
    v_add_f32 v33, v113, v114
    v_add_f32 v34, v112, v115
    v_sub_f32 v35, v114, v113
    ds_write_b64 v20, v[32:33] offset:1536
    ds_write_b64 v29, v[34:35] offset:512
    s_nop 0
    v_mov_b32 v32, v116
    v_mov_b32 v33, v118
    ds_write_b64 v2, v[32:33] offset:2048
    s_waitcnt lgkmcnt(0)
    ds_read_b64 v[32:33], v20 offset:0
    ds_read_b64 v[34:35], v20 offset:512
    ds_read_b64 v[36:37], v20 offset:1024
    ds_read_b64 v[38:39], v20 offset:1536
    ds_read_b64 v[40:41], v20 offset:2048
    ds_read_b64 v[42:43], v20 offset:2560
    ds_read_b64 v[44:45], v20 offset:3072
    ds_read_b64 v[46:47], v20 offset:3584
    s_waitcnt lgkmcnt(0)
    v_pk_add_f32 v[48:49], v[32:33], v[40:41]
    v_pk_add_f32 v[50:51], v[34:35], v[42:43]
    v_pk_add_f32 v[52:53], v[36:37], v[44:45]
    v_pk_add_f32 v[54:55], v[38:39], v[46:47]
    v_pk_add_f32 v[56:57], v[32:33], v[40:41] neg_lo:[0,1] neg_hi:[0,1]
    v_pk_add_f32 v[58:59], v[34:35], v[42:43] neg_lo:[0,1] neg_hi:[0,1]
    v_pk_add_f32 v[60:61], v[36:37], v[44:45] neg_lo:[0,1] neg_hi:[0,1]
    v_pk_add_f32 v[62:63], v[38:39], v[46:47] neg_lo:[0,1] neg_hi:[0,1]
    v_pk_add_f32 v[32:33], v[58:59], v[58:59] op_sel:[0,1] op_sel_hi:[1,0] neg_lo:[0,1]
    v_pk_mul_f32 v[32:33], v[32:33], s[20:21]
    v_pk_add_f32 v[34:35], v[62:63], v[62:63] op_sel:[0,1] op_sel_hi:[0,1] neg_lo:[1,1] neg_hi:[0,1]
    v_pk_mul_f32 v[34:35], v[34:35], s[20:21]
    v_pk_add_f32 v[36:37], v[48:49], v[52:53]
    v_pk_add_f32 v[38:39], v[50:51], v[54:55]
    v_pk_add_f32 v[40:41], v[48:49], v[52:53] neg_lo:[0,1] neg_hi:[0,1]
    v_pk_add_f32 v[42:43], v[50:51], v[54:55] neg_lo:[0,1] neg_hi:[0,1]
    v_pk_add_f32 v[44:45], v[36:37], v[38:39]
    v_pk_add_f32 v[46:47], v[36:37], v[38:39] neg_lo:[0,1] neg_hi:[0,1]
    v_pk_add_f32 v[48:49], v[40:41], v[42:43] op_sel:[0,1] op_sel_hi:[1,0] neg_lo:[0,1]
    v_pk_add_f32 v[50:51], v[40:41], v[42:43] op_sel:[0,1] op_sel_hi:[1,0] neg_hi:[0,1]
    v_pk_add_f32 v[36:37], v[56:57], v[60:61] op_sel:[0,1] op_sel_hi:[1,0] neg_lo:[0,1]
    v_pk_add_f32 v[38:39], v[56:57], v[60:61] op_sel:[0,1] op_sel_hi:[1,0] neg_hi:[0,1]
    v_pk_add_f32 v[40:41], v[32:33], v[34:35]
    v_pk_add_f32 v[42:43], v[32:33], v[34:35] neg_lo:[0,1] neg_hi:[0,1]
    v_pk_add_f32 v[32:33], v[36:37], v[40:41]
    v_pk_add_f32 v[34:35], v[36:37], v[40:41] neg_lo:[0,1] neg_hi:[0,1]
    v_pk_add_f32 v[52:53], v[38:39], v[42:43] op_sel:[0,1] op_sel_hi:[1,0] neg_lo:[0,1]
    v_pk_add_f32 v[54:55], v[38:39], v[42:43] op_sel:[0,1] op_sel_hi:[1,0] neg_hi:[0,1]
    v_mul_f32 v10, 1.0, v24
    v_cos_f32 v36, v10
    v_sin_f32 v37, -v10
    v_mul_f32 v10, 2.0, v24
    v_cos_f32 v38, v10
    v_sin_f32 v39, -v10
    v_mul_f32 v10, 3.0, v24
    v_cos_f32 v40, v10
    v_sin_f32 v41, -v10
    v_mul_f32 v10, 4.0, v24
    v_cos_f32 v42, v10
    v_sin_f32 v43, -v10
    v_mul_f32 v10, 5.0, v24
    v_cos_f32 v56, v10
    v_sin_f32 v57, -v10
    v_mul_f32 v10, 6.0, v24
    v_cos_f32 v58, v10
    v_sin_f32 v59, -v10
    v_mul_f32 v10, 7.0, v24
    v_cos_f32 v60, v10
    v_sin_f32 v61, -v10
    s_nop 0
    v_pk_mul_f32 v[62:63], v[32:33], v[36:37] op_sel:[0,0] op_sel_hi:[0,1] neg_hi:[0,1]
    v_pk_fma_f32 v[62:63], v[32:33], v[36:37], v[62:63] op_sel:[1,1,0] op_sel_hi:[1,0,1]
    v_pk_mul_f32 v[32:33], v[48:49], v[38:39] op_sel:[0,0] op_sel_hi:[0,1] neg_hi:[0,1]
    v_pk_fma_f32 v[32:33], v[48:49], v[38:39], v[32:33] op_sel:[1,1,0] op_sel_hi:[1,0,1]
    v_pk_mul_f32 v[48:49], v[52:53], v[40:41] op_sel:[0,0] op_sel_hi:[0,1] neg_hi:[0,1]
    v_pk_fma_f32 v[48:49], v[52:53], v[40:41], v[48:49] op_sel:[1,1,0] op_sel_hi:[1,0,1]
    v_pk_mul_f32 v[52:53], v[46:47], v[42:43] op_sel:[0,0] op_sel_hi:[0,1] neg_hi:[0,1]
    v_pk_fma_f32 v[52:53], v[46:47], v[42:43], v[52:53] op_sel:[1,1,0] op_sel_hi:[1,0,1]
    v_pk_mul_f32 v[46:47], v[34:35], v[56:57] op_sel:[0,0] op_sel_hi:[0,1] neg_hi:[0,1]
    v_pk_fma_f32 v[46:47], v[34:35], v[56:57], v[46:47] op_sel:[1,1,0] op_sel_hi:[1,0,1]
    v_pk_mul_f32 v[34:35], v[50:51], v[58:59] op_sel:[0,0] op_sel_hi:[0,1] neg_hi:[0,1]
    v_pk_fma_f32 v[34:35], v[50:51], v[58:59], v[34:35] op_sel:[1,1,0] op_sel_hi:[1,0,1]
    v_pk_mul_f32 v[50:51], v[54:55], v[60:61] op_sel:[0,0] op_sel_hi:[0,1] neg_hi:[0,1]
    v_pk_fma_f32 v[50:51], v[54:55], v[60:61], v[50:51] op_sel:[1,1,0] op_sel_hi:[1,0,1]
    ds_write_b64 v20, v[44:45] offset:0
    ds_write_b64 v20, v[62:63] offset:576
    ds_write_b64 v20, v[32:33] offset:1152
    ds_write_b64 v20, v[48:49] offset:1728
    ds_write_b64 v20, v[52:53] offset:2304
    ds_write_b64 v20, v[46:47] offset:2880
    ds_write_b64 v20, v[34:35] offset:3456
    ds_write_b64 v20, v[50:51] offset:4032
    s_waitcnt lgkmcnt(0)
    ds_read_b64 v[32:33], v21 offset:0
    ds_read_b64 v[34:35], v21 offset:64
    ds_read_b64 v[36:37], v21 offset:128
    ds_read_b64 v[38:39], v21 offset:192
    ds_read_b64 v[40:41], v21 offset:256
    ds_read_b64 v[42:43], v21 offset:320
    ds_read_b64 v[44:45], v21 offset:384
    ds_read_b64 v[46:47], v21 offset:448
    s_waitcnt lgkmcnt(0)
    v_pk_add_f32 v[48:49], v[32:33], v[40:41]
    v_pk_add_f32 v[50:51], v[34:35], v[42:43]
    v_pk_add_f32 v[52:53], v[36:37], v[44:45]
    v_pk_add_f32 v[54:55], v[38:39], v[46:47]
    v_pk_add_f32 v[56:57], v[32:33], v[40:41] neg_lo:[0,1] neg_hi:[0,1]
    v_pk_add_f32 v[58:59], v[34:35], v[42:43] neg_lo:[0,1] neg_hi:[0,1]
    v_pk_add_f32 v[60:61], v[36:37], v[44:45] neg_lo:[0,1] neg_hi:[0,1]
    v_pk_add_f32 v[62:63], v[38:39], v[46:47] neg_lo:[0,1] neg_hi:[0,1]
    v_pk_add_f32 v[32:33], v[58:59], v[58:59] op_sel:[0,1] op_sel_hi:[1,0] neg_lo:[0,1]
    v_pk_mul_f32 v[32:33], v[32:33], s[20:21]
    v_pk_add_f32 v[34:35], v[62:63], v[62:63] op_sel:[0,1] op_sel_hi:[0,1] neg_lo:[1,1] neg_hi:[0,1]
    v_pk_mul_f32 v[34:35], v[34:35], s[20:21]
    v_pk_add_f32 v[36:37], v[48:49], v[52:53]
    v_pk_add_f32 v[38:39], v[50:51], v[54:55]
    v_pk_add_f32 v[40:41], v[48:49], v[52:53] neg_lo:[0,1] neg_hi:[0,1]
    v_pk_add_f32 v[42:43], v[50:51], v[54:55] neg_lo:[0,1] neg_hi:[0,1]
    v_pk_add_f32 v[44:45], v[36:37], v[38:39]
    v_pk_add_f32 v[46:47], v[36:37], v[38:39] neg_lo:[0,1] neg_hi:[0,1]
    v_pk_add_f32 v[48:49], v[40:41], v[42:43] op_sel:[0,1] op_sel_hi:[1,0] neg_lo:[0,1]
    v_pk_add_f32 v[50:51], v[40:41], v[42:43] op_sel:[0,1] op_sel_hi:[1,0] neg_hi:[0,1]
    v_pk_add_f32 v[36:37], v[56:57], v[60:61] op_sel:[0,1] op_sel_hi:[1,0] neg_lo:[0,1]
    v_pk_add_f32 v[38:39], v[56:57], v[60:61] op_sel:[0,1] op_sel_hi:[1,0] neg_hi:[0,1]
    v_pk_add_f32 v[40:41], v[32:33], v[34:35]
    v_pk_add_f32 v[42:43], v[32:33], v[34:35] neg_lo:[0,1] neg_hi:[0,1]
    v_pk_add_f32 v[32:33], v[36:37], v[40:41]
    v_pk_add_f32 v[34:35], v[36:37], v[40:41] neg_lo:[0,1] neg_hi:[0,1]
    v_pk_add_f32 v[52:53], v[38:39], v[42:43] op_sel:[0,1] op_sel_hi:[1,0] neg_lo:[0,1]
    v_pk_add_f32 v[54:55], v[38:39], v[42:43] op_sel:[0,1] op_sel_hi:[1,0] neg_hi:[0,1]
    v_mul_f32 v10, 1.0, v25
    v_cos_f32 v36, v10
    v_sin_f32 v37, -v10
    v_mul_f32 v10, 2.0, v25
    v_cos_f32 v38, v10
    v_sin_f32 v39, -v10
    v_mul_f32 v10, 3.0, v25
    v_cos_f32 v40, v10
    v_sin_f32 v41, -v10
    v_mul_f32 v10, 4.0, v25
    v_cos_f32 v42, v10
    v_sin_f32 v43, -v10
    v_mul_f32 v10, 5.0, v25
    v_cos_f32 v56, v10
    v_sin_f32 v57, -v10
    v_mul_f32 v10, 6.0, v25
    v_cos_f32 v58, v10
    v_sin_f32 v59, -v10
    v_mul_f32 v10, 7.0, v25
    v_cos_f32 v60, v10
    v_sin_f32 v61, -v10
    s_nop 0
    v_pk_mul_f32 v[62:63], v[32:33], v[36:37] op_sel:[0,0] op_sel_hi:[0,1] neg_hi:[0,1]
    v_pk_fma_f32 v[62:63], v[32:33], v[36:37], v[62:63] op_sel:[1,1,0] op_sel_hi:[1,0,1]
    v_pk_mul_f32 v[32:33], v[48:49], v[38:39] op_sel:[0,0] op_sel_hi:[0,1] neg_hi:[0,1]
    v_pk_fma_f32 v[32:33], v[48:49], v[38:39], v[32:33] op_sel:[1,1,0] op_sel_hi:[1,0,1]
    v_pk_mul_f32 v[48:49], v[52:53], v[40:41] op_sel:[0,0] op_sel_hi:[0,1] neg_hi:[0,1]
    v_pk_fma_f32 v[48:49], v[52:53], v[40:41], v[48:49] op_sel:[1,1,0] op_sel_hi:[1,0,1]
    v_pk_mul_f32 v[52:53], v[46:47], v[42:43] op_sel:[0,0] op_sel_hi:[0,1] neg_hi:[0,1]
    v_pk_fma_f32 v[52:53], v[46:47], v[42:43], v[52:53] op_sel:[1,1,0] op_sel_hi:[1,0,1]
    v_pk_mul_f32 v[46:47], v[34:35], v[56:57] op_sel:[0,0] op_sel_hi:[0,1] neg_hi:[0,1]
    v_pk_fma_f32 v[46:47], v[34:35], v[56:57], v[46:47] op_sel:[1,1,0] op_sel_hi:[1,0,1]
    v_pk_mul_f32 v[34:35], v[50:51], v[58:59] op_sel:[0,0] op_sel_hi:[0,1] neg_hi:[0,1]
    v_pk_fma_f32 v[34:35], v[50:51], v[58:59], v[34:35] op_sel:[1,1,0] op_sel_hi:[1,0,1]
    v_pk_mul_f32 v[50:51], v[54:55], v[60:61] op_sel:[0,0] op_sel_hi:[0,1] neg_hi:[0,1]
    v_pk_fma_f32 v[50:51], v[54:55], v[60:61], v[50:51] op_sel:[1,1,0] op_sel_hi:[1,0,1]
    ds_write_b64 v22, v[44:45] offset:0
    ds_write_b64 v22, v[62:63] offset:72
    ds_write_b64 v22, v[32:33] offset:144
    ds_write_b64 v22, v[48:49] offset:216
    ds_write_b64 v22, v[52:53] offset:288
    ds_write_b64 v22, v[46:47] offset:360
    ds_write_b64 v22, v[34:35] offset:432
    ds_write_b64 v22, v[50:51] offset:504
    s_waitcnt lgkmcnt(0)
    ds_read_b64 v[32:33], v23 offset:0
    ds_read_b64 v[34:35], v23 offset:8
    ds_read_b64 v[36:37], v23 offset:16
    ds_read_b64 v[38:39], v23 offset:24
    ds_read_b64 v[40:41], v23 offset:32
    ds_read_b64 v[42:43], v23 offset:40
    ds_read_b64 v[44:45], v23 offset:48
    ds_read_b64 v[46:47], v23 offset:56
    s_waitcnt lgkmcnt(0)
    v_pk_add_f32 v[48:49], v[32:33], v[40:41]
    v_pk_add_f32 v[50:51], v[34:35], v[42:43]
    v_pk_add_f32 v[52:53], v[36:37], v[44:45]
    v_pk_add_f32 v[54:55], v[38:39], v[46:47]
    v_pk_add_f32 v[56:57], v[32:33], v[40:41] neg_lo:[0,1] neg_hi:[0,1]
    v_pk_add_f32 v[58:59], v[34:35], v[42:43] neg_lo:[0,1] neg_hi:[0,1]
    v_pk_add_f32 v[60:61], v[36:37], v[44:45] neg_lo:[0,1] neg_hi:[0,1]
    v_pk_add_f32 v[62:63], v[38:39], v[46:47] neg_lo:[0,1] neg_hi:[0,1]
    v_pk_add_f32 v[32:33], v[58:59], v[58:59] op_sel:[0,1] op_sel_hi:[1,0] neg_lo:[0,1]
    v_pk_mul_f32 v[32:33], v[32:33], s[20:21]
    v_pk_add_f32 v[34:35], v[62:63], v[62:63] op_sel:[0,1] op_sel_hi:[0,1] neg_lo:[1,1] neg_hi:[0,1]
    v_pk_mul_f32 v[34:35], v[34:35], s[20:21]
    v_pk_add_f32 v[36:37], v[48:49], v[52:53]
    v_pk_add_f32 v[38:39], v[50:51], v[54:55]
    v_pk_add_f32 v[40:41], v[48:49], v[52:53] neg_lo:[0,1] neg_hi:[0,1]
    v_pk_add_f32 v[42:43], v[50:51], v[54:55] neg_lo:[0,1] neg_hi:[0,1]
    v_pk_add_f32 v[44:45], v[36:37], v[38:39]
    v_pk_add_f32 v[46:47], v[36:37], v[38:39] neg_lo:[0,1] neg_hi:[0,1]
    v_pk_add_f32 v[48:49], v[40:41], v[42:43] op_sel:[0,1] op_sel_hi:[1,0] neg_lo:[0,1]
    v_pk_add_f32 v[50:51], v[40:41], v[42:43] op_sel:[0,1] op_sel_hi:[1,0] neg_hi:[0,1]
    v_pk_add_f32 v[36:37], v[56:57], v[60:61] op_sel:[0,1] op_sel_hi:[1,0] neg_lo:[0,1]
    v_pk_add_f32 v[38:39], v[56:57], v[60:61] op_sel:[0,1] op_sel_hi:[1,0] neg_hi:[0,1]
    v_pk_add_f32 v[40:41], v[32:33], v[34:35]
    v_pk_add_f32 v[42:43], v[32:33], v[34:35] neg_lo:[0,1] neg_hi:[0,1]
    v_pk_add_f32 v[32:33], v[36:37], v[40:41]
    v_pk_add_f32 v[34:35], v[36:37], v[40:41] neg_lo:[0,1] neg_hi:[0,1]
    v_pk_add_f32 v[52:53], v[38:39], v[42:43] op_sel:[0,1] op_sel_hi:[1,0] neg_lo:[0,1]
    v_pk_add_f32 v[54:55], v[38:39], v[42:43] op_sel:[0,1] op_sel_hi:[1,0] neg_hi:[0,1]
    v_lshrrev_b32 v27, 3, v1
    v_and_b32 v28, 7, v1
    v_lshl_add_u32 v27, v28, 3, v27
    v_lshl_add_u32 v27, v27, 3, v2
    ds_write_b64 v27, v[44:45] offset:0
    ds_write_b64 v27, v[32:33] offset:512
    ds_write_b64 v27, v[48:49] offset:1024
    ds_write_b64 v27, v[52:53] offset:1536
    ds_write_b64 v27, v[46:47] offset:2048
    ds_write_b64 v27, v[34:35] offset:2560
    ds_write_b64 v27, v[50:51] offset:3072
    ds_write_b64 v27, v[54:55] offset:3584
    s_waitcnt lgkmcnt(0)
    v_lshlrev_b32 v27, 6, v1
    v_add_u32 v27, v27, v2
    ds_read_b128 v[32:35], v27 offset:0
    ds_read_b128 v[36:39], v27 offset:16
    ds_read_b128 v[40:43], v27 offset:32
    ds_read_b128 v[44:47], v27 offset:48
    s_waitcnt lgkmcnt(0) vmcnt(0)
    v_mul_f32 v32, 0x35000000, v32
    v_mul_f32 v33, 0x35000000, v33
    v_cvt_pk_bf16_f32 v10, v32, v33
    v_lshlrev_b32 v32, 16, v10
    v_and_b32 v33, 0xffff0000, v10
    v_mul_f32 v34, 0x35000000, v34
    v_mul_f32 v35, 0x35000000, v35
    v_cvt_pk_bf16_f32 v10, v34, v35
    v_lshlrev_b32 v34, 16, v10
    v_and_b32 v35, 0xffff0000, v10
    v_mul_f32 v36, 0x35000000, v36
    v_mul_f32 v37, 0x35000000, v37
    v_cvt_pk_bf16_f32 v10, v36, v37
    v_lshlrev_b32 v36, 16, v10
    v_and_b32 v37, 0xffff0000, v10
    v_mul_f32 v38, 0x35000000, v38
    v_mul_f32 v39, 0x35000000, v39
    v_cvt_pk_bf16_f32 v10, v38, v39
    v_lshlrev_b32 v38, 16, v10
    v_and_b32 v39, 0xffff0000, v10
    v_mul_f32 v40, 0x35000000, v40
    v_mul_f32 v41, 0x35000000, v41
    v_cvt_pk_bf16_f32 v10, v40, v41
    v_lshlrev_b32 v40, 16, v10
    v_and_b32 v41, 0xffff0000, v10
    v_mul_f32 v42, 0x35000000, v42
    v_mul_f32 v43, 0x35000000, v43
    v_cvt_pk_bf16_f32 v10, v42, v43
    v_lshlrev_b32 v42, 16, v10
    v_and_b32 v43, 0xffff0000, v10
    v_mul_f32 v44, 0x35000000, v44
    v_mul_f32 v45, 0x35000000, v45
    v_cvt_pk_bf16_f32 v10, v44, v45
    v_lshlrev_b32 v44, 16, v10
    v_and_b32 v45, 0xffff0000, v10
    v_mul_f32 v46, 0x35000000, v46
    v_mul_f32 v47, 0x35000000, v47
    v_cvt_pk_bf16_f32 v10, v46, v47
    v_lshlrev_b32 v46, 16, v10
    v_and_b32 v47, 0xffff0000, v10
    v_lshlrev_b32 v48, 16, v120
    v_and_b32 v49, 0xffff0000, v120
    v_lshlrev_b32 v56, 16, v124
    v_and_b32 v57, 0xffff0000, v124
    v_lshlrev_b32 v50, 16, v121
    v_and_b32 v51, 0xffff0000, v121
    v_lshlrev_b32 v58, 16, v125
    v_and_b32 v59, 0xffff0000, v125
    v_lshlrev_b32 v52, 16, v122
    v_and_b32 v53, 0xffff0000, v122
    v_lshlrev_b32 v60, 16, v126
    v_and_b32 v61, 0xffff0000, v126
    v_lshlrev_b32 v54, 16, v123
    v_and_b32 v55, 0xffff0000, v123
    v_lshlrev_b32 v62, 16, v127
    v_and_b32 v63, 0xffff0000, v127
    v_add_f32 v48, v48, v32
    v_add_f32 v56, v56, v33
    v_add_f32 v49, v49, v34
    v_add_f32 v57, v57, v35
    v_add_f32 v50, v50, v36
    v_add_f32 v58, v58, v37
    v_add_f32 v51, v51, v38
    v_add_f32 v59, v59, v39
    v_add_f32 v52, v52, v40
    v_add_f32 v60, v60, v41
    v_add_f32 v53, v53, v42
    v_add_f32 v61, v61, v43
    v_add_f32 v54, v54, v44
    v_add_f32 v62, v62, v45
    v_add_f32 v55, v55, v46
    v_add_f32 v63, v63, v47
    v_cvt_pk_bf16_f32 v64, v48, v49
    v_cvt_pk_bf16_f32 v68, v56, v57
    v_cvt_pk_bf16_f32 v65, v50, v51
    v_cvt_pk_bf16_f32 v69, v58, v59
    v_cvt_pk_bf16_f32 v66, v52, v53
    v_cvt_pk_bf16_f32 v70, v60, v61
    v_cvt_pk_bf16_f32 v67, v54, v55
    v_cvt_pk_bf16_f32 v71, v62, v63
    v_lshlrev_b32 v48, 16, v64
    v_and_b32 v49, 0xffff0000, v64
    v_lshlrev_b32 v56, 16, v68
    v_and_b32 v57, 0xffff0000, v68
    v_lshlrev_b32 v50, 16, v65
    v_and_b32 v51, 0xffff0000, v65
    v_lshlrev_b32 v58, 16, v69
    v_and_b32 v59, 0xffff0000, v69
    v_lshlrev_b32 v52, 16, v66
    v_and_b32 v53, 0xffff0000, v66
    v_lshlrev_b32 v60, 16, v70
    v_and_b32 v61, 0xffff0000, v70
    v_lshlrev_b32 v54, 16, v67
    v_and_b32 v55, 0xffff0000, v67
    v_lshlrev_b32 v62, 16, v71
    v_and_b32 v63, 0xffff0000, v71
    s_mov_b32 s7, 6422528
    buffer_store_dwordx4 v[64:67], v26, s[24:27], s7 offen
    buffer_store_dwordx4 v[68:71], v26, s[24:27], s7 offen offset:1024
    v_add_f32 v14, v48, v49
    v_add_f32 v14, v14, v50
    v_add_f32 v14, v14, v51
    v_add_f32 v14, v14, v52
    v_add_f32 v14, v14, v53
    v_add_f32 v14, v14, v54
    v_add_f32 v14, v14, v55
    v_add_f32 v15, v56, v57
    v_add_f32 v15, v15, v58
    v_add_f32 v15, v15, v59
    v_add_f32 v15, v15, v60
    v_add_f32 v15, v15, v61
    v_add_f32 v15, v15, v62
    v_add_f32 v15, v15, v63
    ds_bpermute_b32 v10, v4, v14
    ds_bpermute_b32 v11, v4, v15
    s_waitcnt lgkmcnt(0)
    v_add_f32 v14, v14, v10
    v_add_f32 v15, v15, v11
    ds_bpermute_b32 v10, v5, v14
    ds_bpermute_b32 v11, v5, v15
    s_waitcnt lgkmcnt(0)
    v_add_f32 v14, v14, v10
    v_add_f32 v15, v15, v11
    ds_bpermute_b32 v10, v6, v14
    ds_bpermute_b32 v11, v6, v15
    s_waitcnt lgkmcnt(0)
    v_add_f32 v14, v14, v10
    v_add_f32 v15, v15, v11
    ds_bpermute_b32 v10, v7, v14
    ds_bpermute_b32 v11, v7, v15
    s_waitcnt lgkmcnt(0)
    v_add_f32 v14, v14, v10
    v_add_f32 v15, v15, v11
    ds_bpermute_b32 v10, v8, v14
    ds_bpermute_b32 v11, v8, v15
    s_waitcnt lgkmcnt(0)
    v_add_f32 v14, v14, v10
    v_add_f32 v15, v15, v11
    ds_bpermute_b32 v10, v9, v14
    ds_bpermute_b32 v11, v9, v15
    s_waitcnt lgkmcnt(0)
    v_add_f32 v14, v14, v10
    v_add_f32 v15, v15, v11
    v_mul_f32 v14, 0x3b000000, v14
    v_mul_f32 v15, 0x3b000000, v15
    v_sub_f32 v10, v48, v14
    v_mul_f32 v16, v10, v10
    v_sub_f32 v10, v49, v14
    v_fmac_f32 v16, v10, v10
    v_sub_f32 v10, v50, v14
    v_fmac_f32 v16, v10, v10
    v_sub_f32 v10, v51, v14
    v_fmac_f32 v16, v10, v10
    v_sub_f32 v10, v52, v14
    v_fmac_f32 v16, v10, v10
    v_sub_f32 v10, v53, v14
    v_fmac_f32 v16, v10, v10
    v_sub_f32 v10, v54, v14
    v_fmac_f32 v16, v10, v10
    v_sub_f32 v10, v55, v14
    v_fmac_f32 v16, v10, v10
    v_sub_f32 v10, v56, v15
    v_mul_f32 v17, v10, v10
    v_sub_f32 v10, v57, v15
    v_fmac_f32 v17, v10, v10
    v_sub_f32 v10, v58, v15
    v_fmac_f32 v17, v10, v10
    v_sub_f32 v10, v59, v15
    v_fmac_f32 v17, v10, v10
    v_sub_f32 v10, v60, v15
    v_fmac_f32 v17, v10, v10
    v_sub_f32 v10, v61, v15
    v_fmac_f32 v17, v10, v10
    v_sub_f32 v10, v62, v15
    v_fmac_f32 v17, v10, v10
    v_sub_f32 v10, v63, v15
    v_fmac_f32 v17, v10, v10
    ds_bpermute_b32 v10, v4, v16
    ds_bpermute_b32 v11, v4, v17
    s_waitcnt lgkmcnt(0)
    v_add_f32 v16, v16, v10
    v_add_f32 v17, v17, v11
    ds_bpermute_b32 v10, v5, v16
    ds_bpermute_b32 v11, v5, v17
    s_waitcnt lgkmcnt(0)
    v_add_f32 v16, v16, v10
    v_add_f32 v17, v17, v11
    ds_bpermute_b32 v10, v6, v16
    ds_bpermute_b32 v11, v6, v17
    s_waitcnt lgkmcnt(0)
    v_add_f32 v16, v16, v10
    v_add_f32 v17, v17, v11
    ds_bpermute_b32 v10, v7, v16
    ds_bpermute_b32 v11, v7, v17
    s_waitcnt lgkmcnt(0)
    v_add_f32 v16, v16, v10
    v_add_f32 v17, v17, v11
    ds_bpermute_b32 v10, v8, v16
    ds_bpermute_b32 v11, v8, v17
    s_waitcnt lgkmcnt(0)
    v_add_f32 v16, v16, v10
    v_add_f32 v17, v17, v11
    ds_bpermute_b32 v10, v9, v16
    ds_bpermute_b32 v11, v9, v17
    s_waitcnt lgkmcnt(0)
    v_add_f32 v16, v16, v10
    v_add_f32 v17, v17, v11
    v_mul_f32 v16, 0x3b000000, v16
    v_cvt_pk_bf16_f32 v10, v14, v16
    v_lshlrev_b32 v14, 16, v10
    v_and_b32 v16, 0xffff0000, v10
    v_add_f32 v16, 0x3727c5ac, v16
    v_cvt_pk_bf16_f32 v10, v16, v16
    v_lshlrev_b32 v16, 16, v10
    v_sqrt_f32 v16, v16
    s_nop 0
    v_cvt_pk_bf16_f32 v10, v16, v16
    v_lshlrev_b32 v16, 16, v10
    v_rcp_f32 v16, v16
    s_nop 0
    v_mul_f32 v17, 0x3b000000, v17
    v_cvt_pk_bf16_f32 v10, v15, v17
    v_lshlrev_b32 v15, 16, v10
    v_and_b32 v17, 0xffff0000, v10
    v_add_f32 v17, 0x3727c5ac, v17
    v_cvt_pk_bf16_f32 v10, v17, v17
    v_lshlrev_b32 v17, 16, v10
    v_sqrt_f32 v17, v17
    s_nop 0
    v_cvt_pk_bf16_f32 v10, v17, v17
    v_lshlrev_b32 v17, 16, v10
    v_rcp_f32 v17, v17
    s_nop 0
    v_sub_f32 v48, v48, v14
    v_sub_f32 v49, v49, v14
    v_cvt_pk_bf16_f32 v10, v48, v49
    v_lshlrev_b32 v48, 16, v10
    v_and_b32 v49, 0xffff0000, v10
    v_mul_f32 v48, v48, v16
    v_mul_f32 v49, v49, v16
    v_cvt_pk_bf16_f32 v10, v48, v49
    v_lshlrev_b32 v48, 16, v10
    v_and_b32 v49, 0xffff0000, v10
    v_sub_f32 v50, v50, v14
    v_sub_f32 v51, v51, v14
    v_cvt_pk_bf16_f32 v10, v50, v51
    v_lshlrev_b32 v50, 16, v10
    v_and_b32 v51, 0xffff0000, v10
    v_mul_f32 v50, v50, v16
    v_mul_f32 v51, v51, v16
    v_cvt_pk_bf16_f32 v10, v50, v51
    v_lshlrev_b32 v50, 16, v10
    v_and_b32 v51, 0xffff0000, v10
    v_sub_f32 v52, v52, v14
    v_sub_f32 v53, v53, v14
    v_cvt_pk_bf16_f32 v10, v52, v53
    v_lshlrev_b32 v52, 16, v10
    v_and_b32 v53, 0xffff0000, v10
    v_mul_f32 v52, v52, v16
    v_mul_f32 v53, v53, v16
    v_cvt_pk_bf16_f32 v10, v52, v53
    v_lshlrev_b32 v52, 16, v10
    v_and_b32 v53, 0xffff0000, v10
    v_sub_f32 v54, v54, v14
    v_sub_f32 v55, v55, v14
    v_cvt_pk_bf16_f32 v10, v54, v55
    v_lshlrev_b32 v54, 16, v10
    v_and_b32 v55, 0xffff0000, v10
    v_mul_f32 v54, v54, v16
    v_mul_f32 v55, v55, v16
    v_cvt_pk_bf16_f32 v10, v54, v55
    v_lshlrev_b32 v54, 16, v10
    v_and_b32 v55, 0xffff0000, v10
    v_sub_f32 v56, v56, v15
    v_sub_f32 v57, v57, v15
    v_cvt_pk_bf16_f32 v10, v56, v57
    v_lshlrev_b32 v56, 16, v10
    v_and_b32 v57, 0xffff0000, v10
    v_mul_f32 v56, v56, v17
    v_mul_f32 v57, v57, v17
    v_cvt_pk_bf16_f32 v10, v56, v57
    v_lshlrev_b32 v56, 16, v10
    v_and_b32 v57, 0xffff0000, v10
    v_sub_f32 v58, v58, v15
    v_sub_f32 v59, v59, v15
    v_cvt_pk_bf16_f32 v10, v58, v59
    v_lshlrev_b32 v58, 16, v10
    v_and_b32 v59, 0xffff0000, v10
    v_mul_f32 v58, v58, v17
    v_mul_f32 v59, v59, v17
    v_cvt_pk_bf16_f32 v10, v58, v59
    v_lshlrev_b32 v58, 16, v10
    v_and_b32 v59, 0xffff0000, v10
    v_sub_f32 v60, v60, v15
    v_sub_f32 v61, v61, v15
    v_cvt_pk_bf16_f32 v10, v60, v61
    v_lshlrev_b32 v60, 16, v10
    v_and_b32 v61, 0xffff0000, v10
    v_mul_f32 v60, v60, v17
    v_mul_f32 v61, v61, v17
    v_cvt_pk_bf16_f32 v10, v60, v61
    v_lshlrev_b32 v60, 16, v10
    v_and_b32 v61, 0xffff0000, v10
    v_sub_f32 v62, v62, v15
    v_sub_f32 v63, v63, v15
    v_cvt_pk_bf16_f32 v10, v62, v63
    v_lshlrev_b32 v62, 16, v10
    v_and_b32 v63, 0xffff0000, v10
    v_mul_f32 v62, v62, v17
    v_mul_f32 v63, v63, v17
    v_cvt_pk_bf16_f32 v10, v62, v63
    v_lshlrev_b32 v62, 16, v10
    v_and_b32 v63, 0xffff0000, v10
    v_cvt_pk_bf16_f32 v72, v48, v49
    v_cvt_pk_bf16_f32 v76, v56, v57
    v_cvt_pk_bf16_f32 v73, v50, v51
    v_cvt_pk_bf16_f32 v77, v58, v59
    v_cvt_pk_bf16_f32 v74, v52, v53
    v_cvt_pk_bf16_f32 v78, v60, v61
    v_cvt_pk_bf16_f32 v75, v54, v55
    v_cvt_pk_bf16_f32 v79, v62, v63
    s_lshr_b32 s7, s2, 2
    s_lshl_b32 s7, s7, 15
    s_and_b32 s8, s2, 3
    s_lshl_b32 s8, s8, 7
    s_add_u32 s7, s7, s8
    s_add_u32 s7, s7, 8519680
    v_lshrrev_b32 v27, 1, v1
    v_lshlrev_b32 v27, 10, v27
    v_and_b32 v28, 1, v1
    v_lshl_add_u32 v27, v28, 9, v27
    v_lshl_add_u32 v27, v3, 5, v27
    buffer_store_dwordx4 v[72:75], v27, s[24:27], s7 offen
    buffer_store_dwordx4 v[76:79], v27, s[24:27], s7 offen offset:16
k3_kernel_end:
    s_endpgm
.globl k4_kernel
.p2align 8
.type k4_kernel,@function
k4_kernel:
    s_load_dwordx2 s[10:11], s[0:1], 72
    s_cmp_ge_u32 s2, 240
    s_cbranch_scc1 k4_kernel_end
    s_waitcnt lgkmcnt(0)
    s_mov_b32 s24, s10
    s_and_b32 s25, s11, 0xffff
    s_mov_b32 s26, 20971520
    s_mov_b32 s27, 0x00020000
    s_and_b32 s4, s2, 15
    s_lshr_b32 s5, s2, 4
    v_and_b32 v1, 63, v0
    v_lshrrev_b32 v2, 6, v0
    s_nop 1
    v_readfirstlane_b32 s6, v2
    s_nop 3
    v_lshlrev_b32 v3, 4, v1
    s_lshl_b32 s8, s4, 2
    s_add_u32 s8, s8, s6
    s_lshl_b32 s8, s8, 15
    s_add_u32 s8, s8, 8519680
    s_mul_i32 s9, s5, 196608
    s_mul_i32 s12, s6, 6144
    s_add_u32 s9, s9, s12
    s_add_u32 s9, s9, 16384000
    s_lshl_b32 s13, s6, 12
    s_add_u32 s14, s12, 16384
    v_mov_b32 v64, 0
    v_mov_b32 v65, 0
    v_mov_b32 v66, 0
    v_mov_b32 v67, 0
    v_mov_b32 v68, 0
    v_mov_b32 v69, 0
    v_mov_b32 v70, 0
    v_mov_b32 v71, 0
    v_mov_b32 v72, 0
    v_mov_b32 v73, 0
    v_mov_b32 v74, 0
    v_mov_b32 v75, 0
    v_mov_b32 v76, 0
    v_mov_b32 v77, 0
    v_mov_b32 v78, 0
    v_mov_b32 v79, 0
    v_mov_b32 v80, 0
    v_mov_b32 v81, 0
    v_mov_b32 v82, 0
    v_mov_b32 v83, 0
    v_mov_b32 v84, 0
    v_mov_b32 v85, 0
    v_mov_b32 v86, 0
    v_mov_b32 v87, 0
    v_mov_b32 v88, 0
    v_mov_b32 v89, 0
    v_mov_b32 v90, 0
    v_mov_b32 v91, 0
    v_mov_b32 v92, 0
    v_mov_b32 v93, 0
    v_mov_b32 v94, 0
    v_mov_b32 v95, 0
    v_mov_b32 v96, 0
    v_mov_b32 v97, 0
    v_mov_b32 v98, 0
    v_mov_b32 v99, 0
    v_mov_b32 v100, 0
    v_mov_b32 v101, 0
    v_mov_b32 v102, 0
    v_mov_b32 v103, 0
    v_mov_b32 v104, 0
    v_mov_b32 v105, 0
    v_mov_b32 v106, 0
    v_mov_b32 v107, 0
    v_mov_b32 v108, 0
    v_mov_b32 v109, 0
    v_mov_b32 v110, 0
    v_mov_b32 v111, 0
    v_mov_b32 v112, 0
    v_mov_b32 v113, 0
    v_mov_b32 v114, 0
    v_mov_b32 v115, 0
    v_mov_b32 v116, 0
    v_mov_b32 v117, 0
    v_mov_b32 v118, 0
    v_mov_b32 v119, 0
    v_mov_b32 v120, 0
    v_mov_b32 v121, 0
    v_mov_b32 v122, 0
    v_mov_b32 v123, 0
    v_mov_b32 v124, 0
    v_mov_b32 v125, 0
    v_mov_b32 v126, 0
    v_mov_b32 v127, 0
    v_mov_b32 v128, 0
    v_mov_b32 v129, 0
    v_mov_b32 v130, 0
    v_mov_b32 v131, 0
    v_mov_b32 v132, 0
    v_mov_b32 v133, 0
    v_mov_b32 v134, 0
    v_mov_b32 v135, 0
    v_mov_b32 v136, 0
    v_mov_b32 v137, 0
    v_mov_b32 v138, 0
    v_mov_b32 v139, 0
    v_mov_b32 v140, 0
    v_mov_b32 v141, 0
    v_mov_b32 v142, 0
    v_mov_b32 v143, 0
    v_mov_b32 v144, 0
    v_mov_b32 v145, 0
    v_mov_b32 v146, 0
    v_mov_b32 v147, 0
    v_mov_b32 v148, 0
    v_mov_b32 v149, 0
    v_mov_b32 v150, 0
    v_mov_b32 v151, 0
    v_mov_b32 v152, 0
    v_mov_b32 v153, 0
    v_mov_b32 v154, 0
    v_mov_b32 v155, 0
    v_mov_b32 v156, 0
    v_mov_b32 v157, 0
    v_mov_b32 v158, 0
    v_mov_b32 v159, 0
    v_add_u32 v4, s13, v3
    v_add_u32 v5, 16384, v3
    s_add_u32 s15, s13, 0
    s_mov_b32 m0, s15
    s_add_u32 s16, s8, 0
    buffer_load_dwordx4 v3, s[24:27], s16 offen lds
    s_add_u32 s15, s13, 1024
    s_mov_b32 m0, s15
    s_add_u32 s16, s8, 1024
    buffer_load_dwordx4 v3, s[24:27], s16 offen lds
    s_add_u32 s15, s13, 2048
    s_mov_b32 m0, s15
    s_add_u32 s16, s8, 2048
    buffer_load_dwordx4 v3, s[24:27], s16 offen lds
    s_add_u32 s15, s13, 3072
    s_mov_b32 m0, s15
    s_add_u32 s16, s8, 3072
    buffer_load_dwordx4 v3, s[24:27], s16 offen lds
    s_add_u32 s15, s14, 0
    s_mov_b32 m0, s15
    s_add_u32 s16, s9, 0
    buffer_load_dwordx4 v3, s[24:27], s16 offen lds
    s_add_u32 s15, s14, 1024
    s_mov_b32 m0, s15
    s_add_u32 s16, s9, 1024
    buffer_load_dwordx4 v3, s[24:27], s16 offen lds
    s_add_u32 s15, s14, 2048
    s_mov_b32 m0, s15
    s_add_u32 s16, s9, 2048
    buffer_load_dwordx4 v3, s[24:27], s16 offen lds
    s_add_u32 s15, s14, 3072
    s_mov_b32 m0, s15
    s_add_u32 s16, s9, 3072
    buffer_load_dwordx4 v3, s[24:27], s16 offen lds
    s_add_u32 s15, s14, 4096
    s_mov_b32 m0, s15
    s_add_u32 s16, s9, 4096
    buffer_load_dwordx4 v3, s[24:27], s16 offen lds
    s_add_u32 s15, s14, 5120
    s_mov_b32 m0, s15
    s_add_u32 s16, s9, 5120
    buffer_load_dwordx4 v3, s[24:27], s16 offen lds
    s_add_u32 s15, s13, 40960
    s_mov_b32 m0, s15
    s_add_u32 s16, s8, 4096
    buffer_load_dwordx4 v3, s[24:27], s16 offen lds
    s_add_u32 s15, s13, 41984
    s_mov_b32 m0, s15
    s_add_u32 s16, s8, 5120
    buffer_load_dwordx4 v3, s[24:27], s16 offen lds
    s_add_u32 s15, s13, 43008
    s_mov_b32 m0, s15
    s_add_u32 s16, s8, 6144
    buffer_load_dwordx4 v3, s[24:27], s16 offen lds
    s_add_u32 s15, s13, 44032
    s_mov_b32 m0, s15
    s_add_u32 s16, s8, 7168
    buffer_load_dwordx4 v3, s[24:27], s16 offen lds
    s_add_u32 s15, s14, 40960
    s_mov_b32 m0, s15
    s_add_u32 s16, s9, 24576
    buffer_load_dwordx4 v3, s[24:27], s16 offen lds
    s_add_u32 s15, s14, 41984
    s_mov_b32 m0, s15
    s_add_u32 s16, s9, 25600
    buffer_load_dwordx4 v3, s[24:27], s16 offen lds
    s_add_u32 s15, s14, 43008
    s_mov_b32 m0, s15
    s_add_u32 s16, s9, 26624
    buffer_load_dwordx4 v3, s[24:27], s16 offen lds
    s_add_u32 s15, s14, 44032
    s_mov_b32 m0, s15
    s_add_u32 s16, s9, 27648
    buffer_load_dwordx4 v3, s[24:27], s16 offen lds
    s_add_u32 s15, s14, 45056
    s_mov_b32 m0, s15
    s_add_u32 s16, s9, 28672
    buffer_load_dwordx4 v3, s[24:27], s16 offen lds
    s_add_u32 s15, s14, 46080
    s_mov_b32 m0, s15
    s_add_u32 s16, s9, 29696
    buffer_load_dwordx4 v3, s[24:27], s16 offen lds
    s_waitcnt vmcnt(10)
    s_barrier
    ds_read_b128 v[8:11], v4 offset:0
    ds_read_b128 v[12:15], v5 offset:0
    ds_read_b128 v[16:19], v5 offset:1024
    ds_read_b128 v[20:23], v5 offset:2048
    ds_read_b128 v[24:27], v5 offset:3072
    ds_read_b128 v[28:31], v5 offset:4096
    ds_read_b128 v[32:35], v5 offset:5120
    s_waitcnt lgkmcnt(0)
    v_mfma_f32_32x32x16_bf16 v[64:79], v[8:11], v[12:15], v[64:79]
    v_mfma_f32_32x32x16_bf16 v[80:95], v[8:11], v[16:19], v[80:95]
    v_mfma_f32_32x32x16_bf16 v[96:111], v[8:11], v[20:23], v[96:111]
    v_mfma_f32_32x32x16_bf16 v[112:127], v[8:11], v[24:27], v[112:127]
    v_mfma_f32_32x32x16_bf16 v[128:143], v[8:11], v[28:31], v[128:143]
    v_mfma_f32_32x32x16_bf16 v[144:159], v[8:11], v[32:35], v[144:159]
    ds_read_b128 v[36:39], v4 offset:1024
    ds_read_b128 v[40:43], v5 offset:6144
    ds_read_b128 v[44:47], v5 offset:7168
    ds_read_b128 v[48:51], v5 offset:8192
    ds_read_b128 v[52:55], v5 offset:9216
    ds_read_b128 v[56:59], v5 offset:10240
    ds_read_b128 v[60:63], v5 offset:11264
    s_waitcnt lgkmcnt(0)
    v_mfma_f32_32x32x16_bf16 v[64:79], v[36:39], v[40:43], v[64:79]
    v_mfma_f32_32x32x16_bf16 v[80:95], v[36:39], v[44:47], v[80:95]
    v_mfma_f32_32x32x16_bf16 v[96:111], v[36:39], v[48:51], v[96:111]
    v_mfma_f32_32x32x16_bf16 v[112:127], v[36:39], v[52:55], v[112:127]
    v_mfma_f32_32x32x16_bf16 v[128:143], v[36:39], v[56:59], v[128:143]
    v_mfma_f32_32x32x16_bf16 v[144:159], v[36:39], v[60:63], v[144:159]
    ds_read_b128 v[8:11], v4 offset:2048
    ds_read_b128 v[12:15], v5 offset:12288
    ds_read_b128 v[16:19], v5 offset:13312
    ds_read_b128 v[20:23], v5 offset:14336
    ds_read_b128 v[24:27], v5 offset:15360
    ds_read_b128 v[28:31], v5 offset:16384
    ds_read_b128 v[32:35], v5 offset:17408
    s_waitcnt lgkmcnt(0)
    v_mfma_f32_32x32x16_bf16 v[64:79], v[8:11], v[12:15], v[64:79]
    v_mfma_f32_32x32x16_bf16 v[80:95], v[8:11], v[16:19], v[80:95]
    v_mfma_f32_32x32x16_bf16 v[96:111], v[8:11], v[20:23], v[96:111]
    v_mfma_f32_32x32x16_bf16 v[112:127], v[8:11], v[24:27], v[112:127]
    v_mfma_f32_32x32x16_bf16 v[128:143], v[8:11], v[28:31], v[128:143]
    v_mfma_f32_32x32x16_bf16 v[144:159], v[8:11], v[32:35], v[144:159]
    ds_read_b128 v[36:39], v4 offset:3072
    ds_read_b128 v[40:43], v5 offset:18432
    ds_read_b128 v[44:47], v5 offset:19456
    ds_read_b128 v[48:51], v5 offset:20480
    ds_read_b128 v[52:55], v5 offset:21504
    ds_read_b128 v[56:59], v5 offset:22528
    ds_read_b128 v[60:63], v5 offset:23552
    s_waitcnt lgkmcnt(0)
    v_mfma_f32_32x32x16_bf16 v[64:79], v[36:39], v[40:43], v[64:79]
    v_mfma_f32_32x32x16_bf16 v[80:95], v[36:39], v[44:47], v[80:95]
    v_mfma_f32_32x32x16_bf16 v[96:111], v[36:39], v[48:51], v[96:111]
    v_mfma_f32_32x32x16_bf16 v[112:127], v[36:39], v[52:55], v[112:127]
    v_mfma_f32_32x32x16_bf16 v[128:143], v[36:39], v[56:59], v[128:143]
    v_mfma_f32_32x32x16_bf16 v[144:159], v[36:39], v[60:63], v[144:159]
    s_barrier
    s_add_u32 s15, s13, 0
    s_mov_b32 m0, s15
    s_add_u32 s16, s8, 8192
    buffer_load_dwordx4 v3, s[24:27], s16 offen lds
    s_add_u32 s15, s13, 1024
    s_mov_b32 m0, s15
    s_add_u32 s16, s8, 9216
    buffer_load_dwordx4 v3, s[24:27], s16 offen lds
    s_add_u32 s15, s13, 2048
    s_mov_b32 m0, s15
    s_add_u32 s16, s8, 10240
    buffer_load_dwordx4 v3, s[24:27], s16 offen lds
    s_add_u32 s15, s13, 3072
    s_mov_b32 m0, s15
    s_add_u32 s16, s8, 11264
    buffer_load_dwordx4 v3, s[24:27], s16 offen lds
    s_add_u32 s15, s14, 0
    s_mov_b32 m0, s15
    s_add_u32 s16, s9, 49152
    buffer_load_dwordx4 v3, s[24:27], s16 offen lds
    s_add_u32 s15, s14, 1024
    s_mov_b32 m0, s15
    s_add_u32 s16, s9, 50176
    buffer_load_dwordx4 v3, s[24:27], s16 offen lds
    s_add_u32 s15, s14, 2048
    s_mov_b32 m0, s15
    s_add_u32 s16, s9, 51200
    buffer_load_dwordx4 v3, s[24:27], s16 offen lds
    s_add_u32 s15, s14, 3072
    s_mov_b32 m0, s15
    s_add_u32 s16, s9, 52224
    buffer_load_dwordx4 v3, s[24:27], s16 offen lds
    s_add_u32 s15, s14, 4096
    s_mov_b32 m0, s15
    s_add_u32 s16, s9, 53248
    buffer_load_dwordx4 v3, s[24:27], s16 offen lds
    s_add_u32 s15, s14, 5120
    s_mov_b32 m0, s15
    s_add_u32 s16, s9, 54272
    buffer_load_dwordx4 v3, s[24:27], s16 offen lds
    s_waitcnt vmcnt(10)
    s_barrier
    ds_read_b128 v[8:11], v4 offset:40960
    ds_read_b128 v[12:15], v5 offset:40960
    ds_read_b128 v[16:19], v5 offset:41984
    ds_read_b128 v[20:23], v5 offset:43008
    ds_read_b128 v[24:27], v5 offset:44032
    ds_read_b128 v[28:31], v5 offset:45056
    ds_read_b128 v[32:35], v5 offset:46080
    s_waitcnt lgkmcnt(0)
    v_mfma_f32_32x32x16_bf16 v[64:79], v[8:11], v[12:15], v[64:79]
    v_mfma_f32_32x32x16_bf16 v[80:95], v[8:11], v[16:19], v[80:95]
    v_mfma_f32_32x32x16_bf16 v[96:111], v[8:11], v[20:23], v[96:111]
    v_mfma_f32_32x32x16_bf16 v[112:127], v[8:11], v[24:27], v[112:127]
    v_mfma_f32_32x32x16_bf16 v[128:143], v[8:11], v[28:31], v[128:143]
    v_mfma_f32_32x32x16_bf16 v[144:159], v[8:11], v[32:35], v[144:159]
    ds_read_b128 v[36:39], v4 offset:41984
    ds_read_b128 v[40:43], v5 offset:47104
    ds_read_b128 v[44:47], v5 offset:48128
    ds_read_b128 v[48:51], v5 offset:49152
    ds_read_b128 v[52:55], v5 offset:50176
    ds_read_b128 v[56:59], v5 offset:51200
    ds_read_b128 v[60:63], v5 offset:52224
    s_waitcnt lgkmcnt(0)
    v_mfma_f32_32x32x16_bf16 v[64:79], v[36:39], v[40:43], v[64:79]
    v_mfma_f32_32x32x16_bf16 v[80:95], v[36:39], v[44:47], v[80:95]
    v_mfma_f32_32x32x16_bf16 v[96:111], v[36:39], v[48:51], v[96:111]
    v_mfma_f32_32x32x16_bf16 v[112:127], v[36:39], v[52:55], v[112:127]
    v_mfma_f32_32x32x16_bf16 v[128:143], v[36:39], v[56:59], v[128:143]
    v_mfma_f32_32x32x16_bf16 v[144:159], v[36:39], v[60:63], v[144:159]
    ds_read_b128 v[8:11], v4 offset:43008
    ds_read_b128 v[12:15], v5 offset:53248
    ds_read_b128 v[16:19], v5 offset:54272
    ds_read_b128 v[20:23], v5 offset:55296
    ds_read_b128 v[24:27], v5 offset:56320
    ds_read_b128 v[28:31], v5 offset:57344
    ds_read_b128 v[32:35], v5 offset:58368
    s_waitcnt lgkmcnt(0)
    v_mfma_f32_32x32x16_bf16 v[64:79], v[8:11], v[12:15], v[64:79]
    v_mfma_f32_32x32x16_bf16 v[80:95], v[8:11], v[16:19], v[80:95]
    v_mfma_f32_32x32x16_bf16 v[96:111], v[8:11], v[20:23], v[96:111]
    v_mfma_f32_32x32x16_bf16 v[112:127], v[8:11], v[24:27], v[112:127]
    v_mfma_f32_32x32x16_bf16 v[128:143], v[8:11], v[28:31], v[128:143]
    v_mfma_f32_32x32x16_bf16 v[144:159], v[8:11], v[32:35], v[144:159]
    ds_read_b128 v[36:39], v4 offset:44032
    ds_read_b128 v[40:43], v5 offset:59392
    ds_read_b128 v[44:47], v5 offset:60416
    ds_read_b128 v[48:51], v5 offset:61440
    ds_read_b128 v[52:55], v5 offset:62464
    ds_read_b128 v[56:59], v5 offset:63488
    ds_read_b128 v[60:63], v5 offset:64512
    s_waitcnt lgkmcnt(0)
    v_mfma_f32_32x32x16_bf16 v[64:79], v[36:39], v[40:43], v[64:79]
    v_mfma_f32_32x32x16_bf16 v[80:95], v[36:39], v[44:47], v[80:95]
    v_mfma_f32_32x32x16_bf16 v[96:111], v[36:39], v[48:51], v[96:111]
    v_mfma_f32_32x32x16_bf16 v[112:127], v[36:39], v[52:55], v[112:127]
    v_mfma_f32_32x32x16_bf16 v[128:143], v[36:39], v[56:59], v[128:143]
    v_mfma_f32_32x32x16_bf16 v[144:159], v[36:39], v[60:63], v[144:159]
    s_barrier
    s_add_u32 s15, s13, 40960
    s_mov_b32 m0, s15
    s_add_u32 s16, s8, 12288
    buffer_load_dwordx4 v3, s[24:27], s16 offen lds
    s_add_u32 s15, s13, 41984
    s_mov_b32 m0, s15
    s_add_u32 s16, s8, 13312
    buffer_load_dwordx4 v3, s[24:27], s16 offen lds
    s_add_u32 s15, s13, 43008
    s_mov_b32 m0, s15
    s_add_u32 s16, s8, 14336
    buffer_load_dwordx4 v3, s[24:27], s16 offen lds
    s_add_u32 s15, s13, 44032
    s_mov_b32 m0, s15
    s_add_u32 s16, s8, 15360
    buffer_load_dwordx4 v3, s[24:27], s16 offen lds
    s_add_u32 s15, s14, 40960
    s_mov_b32 m0, s15
    s_add_u32 s16, s9, 73728
    buffer_load_dwordx4 v3, s[24:27], s16 offen lds
    s_add_u32 s15, s14, 41984
    s_mov_b32 m0, s15
    s_add_u32 s16, s9, 74752
    buffer_load_dwordx4 v3, s[24:27], s16 offen lds
    s_add_u32 s15, s14, 43008
    s_mov_b32 m0, s15
    s_add_u32 s16, s9, 75776
    buffer_load_dwordx4 v3, s[24:27], s16 offen lds
    s_add_u32 s15, s14, 44032
    s_mov_b32 m0, s15
    s_add_u32 s16, s9, 76800
    buffer_load_dwordx4 v3, s[24:27], s16 offen lds
    s_add_u32 s15, s14, 45056
    s_mov_b32 m0, s15
    s_add_u32 s16, s9, 77824
    buffer_load_dwordx4 v3, s[24:27], s16 offen lds
    s_add_u32 s15, s14, 46080
    s_mov_b32 m0, s15
    s_add_u32 s16, s9, 78848
    buffer_load_dwordx4 v3, s[24:27], s16 offen lds
    s_waitcnt vmcnt(10)
    s_barrier
    ds_read_b128 v[8:11], v4 offset:0
    ds_read_b128 v[12:15], v5 offset:0
    ds_read_b128 v[16:19], v5 offset:1024
    ds_read_b128 v[20:23], v5 offset:2048
    ds_read_b128 v[24:27], v5 offset:3072
    ds_read_b128 v[28:31], v5 offset:4096
    ds_read_b128 v[32:35], v5 offset:5120
    s_waitcnt lgkmcnt(0)
    v_mfma_f32_32x32x16_bf16 v[64:79], v[8:11], v[12:15], v[64:79]
    v_mfma_f32_32x32x16_bf16 v[80:95], v[8:11], v[16:19], v[80:95]
    v_mfma_f32_32x32x16_bf16 v[96:111], v[8:11], v[20:23], v[96:111]
    v_mfma_f32_32x32x16_bf16 v[112:127], v[8:11], v[24:27], v[112:127]
    v_mfma_f32_32x32x16_bf16 v[128:143], v[8:11], v[28:31], v[128:143]
    v_mfma_f32_32x32x16_bf16 v[144:159], v[8:11], v[32:35], v[144:159]
    ds_read_b128 v[36:39], v4 offset:1024
    ds_read_b128 v[40:43], v5 offset:6144
    ds_read_b128 v[44:47], v5 offset:7168
    ds_read_b128 v[48:51], v5 offset:8192
    ds_read_b128 v[52:55], v5 offset:9216
    ds_read_b128 v[56:59], v5 offset:10240
    ds_read_b128 v[60:63], v5 offset:11264
    s_waitcnt lgkmcnt(0)
    v_mfma_f32_32x32x16_bf16 v[64:79], v[36:39], v[40:43], v[64:79]
    v_mfma_f32_32x32x16_bf16 v[80:95], v[36:39], v[44:47], v[80:95]
    v_mfma_f32_32x32x16_bf16 v[96:111], v[36:39], v[48:51], v[96:111]
    v_mfma_f32_32x32x16_bf16 v[112:127], v[36:39], v[52:55], v[112:127]
    v_mfma_f32_32x32x16_bf16 v[128:143], v[36:39], v[56:59], v[128:143]
    v_mfma_f32_32x32x16_bf16 v[144:159], v[36:39], v[60:63], v[144:159]
    ds_read_b128 v[8:11], v4 offset:2048
    ds_read_b128 v[12:15], v5 offset:12288
    ds_read_b128 v[16:19], v5 offset:13312
    ds_read_b128 v[20:23], v5 offset:14336
    ds_read_b128 v[24:27], v5 offset:15360
    ds_read_b128 v[28:31], v5 offset:16384
    ds_read_b128 v[32:35], v5 offset:17408
    s_waitcnt lgkmcnt(0)
    v_mfma_f32_32x32x16_bf16 v[64:79], v[8:11], v[12:15], v[64:79]
    v_mfma_f32_32x32x16_bf16 v[80:95], v[8:11], v[16:19], v[80:95]
    v_mfma_f32_32x32x16_bf16 v[96:111], v[8:11], v[20:23], v[96:111]
    v_mfma_f32_32x32x16_bf16 v[112:127], v[8:11], v[24:27], v[112:127]
    v_mfma_f32_32x32x16_bf16 v[128:143], v[8:11], v[28:31], v[128:143]
    v_mfma_f32_32x32x16_bf16 v[144:159], v[8:11], v[32:35], v[144:159]
    ds_read_b128 v[36:39], v4 offset:3072
    ds_read_b128 v[40:43], v5 offset:18432
    ds_read_b128 v[44:47], v5 offset:19456
    ds_read_b128 v[48:51], v5 offset:20480
    ds_read_b128 v[52:55], v5 offset:21504
    ds_read_b128 v[56:59], v5 offset:22528
    ds_read_b128 v[60:63], v5 offset:23552
    s_waitcnt lgkmcnt(0)
    v_mfma_f32_32x32x16_bf16 v[64:79], v[36:39], v[40:43], v[64:79]
    v_mfma_f32_32x32x16_bf16 v[80:95], v[36:39], v[44:47], v[80:95]
    v_mfma_f32_32x32x16_bf16 v[96:111], v[36:39], v[48:51], v[96:111]
    v_mfma_f32_32x32x16_bf16 v[112:127], v[36:39], v[52:55], v[112:127]
    v_mfma_f32_32x32x16_bf16 v[128:143], v[36:39], v[56:59], v[128:143]
    v_mfma_f32_32x32x16_bf16 v[144:159], v[36:39], v[60:63], v[144:159]
    s_barrier
    s_add_u32 s15, s13, 0
    s_mov_b32 m0, s15
    s_add_u32 s16, s8, 16384
    buffer_load_dwordx4 v3, s[24:27], s16 offen lds
    s_add_u32 s15, s13, 1024
    s_mov_b32 m0, s15
    s_add_u32 s16, s8, 17408
    buffer_load_dwordx4 v3, s[24:27], s16 offen lds
    s_add_u32 s15, s13, 2048
    s_mov_b32 m0, s15
    s_add_u32 s16, s8, 18432
    buffer_load_dwordx4 v3, s[24:27], s16 offen lds
    s_add_u32 s15, s13, 3072
    s_mov_b32 m0, s15
    s_add_u32 s16, s8, 19456
    buffer_load_dwordx4 v3, s[24:27], s16 offen lds
    s_add_u32 s15, s14, 0
    s_mov_b32 m0, s15
    s_add_u32 s16, s9, 98304
    buffer_load_dwordx4 v3, s[24:27], s16 offen lds
    s_add_u32 s15, s14, 1024
    s_mov_b32 m0, s15
    s_add_u32 s16, s9, 99328
    buffer_load_dwordx4 v3, s[24:27], s16 offen lds
    s_add_u32 s15, s14, 2048
    s_mov_b32 m0, s15
    s_add_u32 s16, s9, 100352
    buffer_load_dwordx4 v3, s[24:27], s16 offen lds
    s_add_u32 s15, s14, 3072
    s_mov_b32 m0, s15
    s_add_u32 s16, s9, 101376
    buffer_load_dwordx4 v3, s[24:27], s16 offen lds
    s_add_u32 s15, s14, 4096
    s_mov_b32 m0, s15
    s_add_u32 s16, s9, 102400
    buffer_load_dwordx4 v3, s[24:27], s16 offen lds
    s_add_u32 s15, s14, 5120
    s_mov_b32 m0, s15
    s_add_u32 s16, s9, 103424
    buffer_load_dwordx4 v3, s[24:27], s16 offen lds
    s_waitcnt vmcnt(10)
    s_barrier
    ds_read_b128 v[8:11], v4 offset:40960
    ds_read_b128 v[12:15], v5 offset:40960
    ds_read_b128 v[16:19], v5 offset:41984
    ds_read_b128 v[20:23], v5 offset:43008
    ds_read_b128 v[24:27], v5 offset:44032
    ds_read_b128 v[28:31], v5 offset:45056
    ds_read_b128 v[32:35], v5 offset:46080
    s_waitcnt lgkmcnt(0)
    v_mfma_f32_32x32x16_bf16 v[64:79], v[8:11], v[12:15], v[64:79]
    v_mfma_f32_32x32x16_bf16 v[80:95], v[8:11], v[16:19], v[80:95]
    v_mfma_f32_32x32x16_bf16 v[96:111], v[8:11], v[20:23], v[96:111]
    v_mfma_f32_32x32x16_bf16 v[112:127], v[8:11], v[24:27], v[112:127]
    v_mfma_f32_32x32x16_bf16 v[128:143], v[8:11], v[28:31], v[128:143]
    v_mfma_f32_32x32x16_bf16 v[144:159], v[8:11], v[32:35], v[144:159]
    ds_read_b128 v[36:39], v4 offset:41984
    ds_read_b128 v[40:43], v5 offset:47104
    ds_read_b128 v[44:47], v5 offset:48128
    ds_read_b128 v[48:51], v5 offset:49152
    ds_read_b128 v[52:55], v5 offset:50176
    ds_read_b128 v[56:59], v5 offset:51200
    ds_read_b128 v[60:63], v5 offset:52224
    s_waitcnt lgkmcnt(0)
    v_mfma_f32_32x32x16_bf16 v[64:79], v[36:39], v[40:43], v[64:79]
    v_mfma_f32_32x32x16_bf16 v[80:95], v[36:39], v[44:47], v[80:95]
    v_mfma_f32_32x32x16_bf16 v[96:111], v[36:39], v[48:51], v[96:111]
    v_mfma_f32_32x32x16_bf16 v[112:127], v[36:39], v[52:55], v[112:127]
    v_mfma_f32_32x32x16_bf16 v[128:143], v[36:39], v[56:59], v[128:143]
    v_mfma_f32_32x32x16_bf16 v[144:159], v[36:39], v[60:63], v[144:159]
    ds_read_b128 v[8:11], v4 offset:43008
    ds_read_b128 v[12:15], v5 offset:53248
    ds_read_b128 v[16:19], v5 offset:54272
    ds_read_b128 v[20:23], v5 offset:55296
    ds_read_b128 v[24:27], v5 offset:56320
    ds_read_b128 v[28:31], v5 offset:57344
    ds_read_b128 v[32:35], v5 offset:58368
    s_waitcnt lgkmcnt(0)
    v_mfma_f32_32x32x16_bf16 v[64:79], v[8:11], v[12:15], v[64:79]
    v_mfma_f32_32x32x16_bf16 v[80:95], v[8:11], v[16:19], v[80:95]
    v_mfma_f32_32x32x16_bf16 v[96:111], v[8:11], v[20:23], v[96:111]
    v_mfma_f32_32x32x16_bf16 v[112:127], v[8:11], v[24:27], v[112:127]
    v_mfma_f32_32x32x16_bf16 v[128:143], v[8:11], v[28:31], v[128:143]
    v_mfma_f32_32x32x16_bf16 v[144:159], v[8:11], v[32:35], v[144:159]
    ds_read_b128 v[36:39], v4 offset:44032
    ds_read_b128 v[40:43], v5 offset:59392
    ds_read_b128 v[44:47], v5 offset:60416
    ds_read_b128 v[48:51], v5 offset:61440
    ds_read_b128 v[52:55], v5 offset:62464
    ds_read_b128 v[56:59], v5 offset:63488
    ds_read_b128 v[60:63], v5 offset:64512
    s_waitcnt lgkmcnt(0)
    v_mfma_f32_32x32x16_bf16 v[64:79], v[36:39], v[40:43], v[64:79]
    v_mfma_f32_32x32x16_bf16 v[80:95], v[36:39], v[44:47], v[80:95]
    v_mfma_f32_32x32x16_bf16 v[96:111], v[36:39], v[48:51], v[96:111]
    v_mfma_f32_32x32x16_bf16 v[112:127], v[36:39], v[52:55], v[112:127]
    v_mfma_f32_32x32x16_bf16 v[128:143], v[36:39], v[56:59], v[128:143]
    v_mfma_f32_32x32x16_bf16 v[144:159], v[36:39], v[60:63], v[144:159]
    s_barrier
    s_add_u32 s15, s13, 40960
    s_mov_b32 m0, s15
    s_add_u32 s16, s8, 20480
    buffer_load_dwordx4 v3, s[24:27], s16 offen lds
    s_add_u32 s15, s13, 41984
    s_mov_b32 m0, s15
    s_add_u32 s16, s8, 21504
    buffer_load_dwordx4 v3, s[24:27], s16 offen lds
    s_add_u32 s15, s13, 43008
    s_mov_b32 m0, s15
    s_add_u32 s16, s8, 22528
    buffer_load_dwordx4 v3, s[24:27], s16 offen lds
    s_add_u32 s15, s13, 44032
    s_mov_b32 m0, s15
    s_add_u32 s16, s8, 23552
    buffer_load_dwordx4 v3, s[24:27], s16 offen lds
    s_add_u32 s15, s14, 40960
    s_mov_b32 m0, s15
    s_add_u32 s16, s9, 122880
    buffer_load_dwordx4 v3, s[24:27], s16 offen lds
    s_add_u32 s15, s14, 41984
    s_mov_b32 m0, s15
    s_add_u32 s16, s9, 123904
    buffer_load_dwordx4 v3, s[24:27], s16 offen lds
    s_add_u32 s15, s14, 43008
    s_mov_b32 m0, s15
    s_add_u32 s16, s9, 124928
    buffer_load_dwordx4 v3, s[24:27], s16 offen lds
    s_add_u32 s15, s14, 44032
    s_mov_b32 m0, s15
    s_add_u32 s16, s9, 125952
    buffer_load_dwordx4 v3, s[24:27], s16 offen lds
    s_add_u32 s15, s14, 45056
    s_mov_b32 m0, s15
    s_add_u32 s16, s9, 126976
    buffer_load_dwordx4 v3, s[24:27], s16 offen lds
    s_add_u32 s15, s14, 46080
    s_mov_b32 m0, s15
    s_add_u32 s16, s9, 128000
    buffer_load_dwordx4 v3, s[24:27], s16 offen lds
    s_waitcnt vmcnt(10)
    s_barrier
    ds_read_b128 v[8:11], v4 offset:0
    ds_read_b128 v[12:15], v5 offset:0
    ds_read_b128 v[16:19], v5 offset:1024
    ds_read_b128 v[20:23], v5 offset:2048
    ds_read_b128 v[24:27], v5 offset:3072
    ds_read_b128 v[28:31], v5 offset:4096
    ds_read_b128 v[32:35], v5 offset:5120
    s_waitcnt lgkmcnt(0)
    v_mfma_f32_32x32x16_bf16 v[64:79], v[8:11], v[12:15], v[64:79]
    v_mfma_f32_32x32x16_bf16 v[80:95], v[8:11], v[16:19], v[80:95]
    v_mfma_f32_32x32x16_bf16 v[96:111], v[8:11], v[20:23], v[96:111]
    v_mfma_f32_32x32x16_bf16 v[112:127], v[8:11], v[24:27], v[112:127]
    v_mfma_f32_32x32x16_bf16 v[128:143], v[8:11], v[28:31], v[128:143]
    v_mfma_f32_32x32x16_bf16 v[144:159], v[8:11], v[32:35], v[144:159]
    ds_read_b128 v[36:39], v4 offset:1024
    ds_read_b128 v[40:43], v5 offset:6144
    ds_read_b128 v[44:47], v5 offset:7168
    ds_read_b128 v[48:51], v5 offset:8192
    ds_read_b128 v[52:55], v5 offset:9216
    ds_read_b128 v[56:59], v5 offset:10240
    ds_read_b128 v[60:63], v5 offset:11264
    s_waitcnt lgkmcnt(0)
    v_mfma_f32_32x32x16_bf16 v[64:79], v[36:39], v[40:43], v[64:79]
    v_mfma_f32_32x32x16_bf16 v[80:95], v[36:39], v[44:47], v[80:95]
    v_mfma_f32_32x32x16_bf16 v[96:111], v[36:39], v[48:51], v[96:111]
    v_mfma_f32_32x32x16_bf16 v[112:127], v[36:39], v[52:55], v[112:127]
    v_mfma_f32_32x32x16_bf16 v[128:143], v[36:39], v[56:59], v[128:143]
    v_mfma_f32_32x32x16_bf16 v[144:159], v[36:39], v[60:63], v[144:159]
    ds_read_b128 v[8:11], v4 offset:2048
    ds_read_b128 v[12:15], v5 offset:12288
    ds_read_b128 v[16:19], v5 offset:13312
    ds_read_b128 v[20:23], v5 offset:14336
    ds_read_b128 v[24:27], v5 offset:15360
    ds_read_b128 v[28:31], v5 offset:16384
    ds_read_b128 v[32:35], v5 offset:17408
    s_waitcnt lgkmcnt(0)
    v_mfma_f32_32x32x16_bf16 v[64:79], v[8:11], v[12:15], v[64:79]
    v_mfma_f32_32x32x16_bf16 v[80:95], v[8:11], v[16:19], v[80:95]
    v_mfma_f32_32x32x16_bf16 v[96:111], v[8:11], v[20:23], v[96:111]
    v_mfma_f32_32x32x16_bf16 v[112:127], v[8:11], v[24:27], v[112:127]
    v_mfma_f32_32x32x16_bf16 v[128:143], v[8:11], v[28:31], v[128:143]
    v_mfma_f32_32x32x16_bf16 v[144:159], v[8:11], v[32:35], v[144:159]
    ds_read_b128 v[36:39], v4 offset:3072
    ds_read_b128 v[40:43], v5 offset:18432
    ds_read_b128 v[44:47], v5 offset:19456
    ds_read_b128 v[48:51], v5 offset:20480
    ds_read_b128 v[52:55], v5 offset:21504
    ds_read_b128 v[56:59], v5 offset:22528
    ds_read_b128 v[60:63], v5 offset:23552
    s_waitcnt lgkmcnt(0)
    v_mfma_f32_32x32x16_bf16 v[64:79], v[36:39], v[40:43], v[64:79]
    v_mfma_f32_32x32x16_bf16 v[80:95], v[36:39], v[44:47], v[80:95]
    v_mfma_f32_32x32x16_bf16 v[96:111], v[36:39], v[48:51], v[96:111]
    v_mfma_f32_32x32x16_bf16 v[112:127], v[36:39], v[52:55], v[112:127]
    v_mfma_f32_32x32x16_bf16 v[128:143], v[36:39], v[56:59], v[128:143]
    v_mfma_f32_32x32x16_bf16 v[144:159], v[36:39], v[60:63], v[144:159]
    s_barrier
    s_add_u32 s15, s13, 0
    s_mov_b32 m0, s15
    s_add_u32 s16, s8, 24576
    buffer_load_dwordx4 v3, s[24:27], s16 offen lds
    s_add_u32 s15, s13, 1024
    s_mov_b32 m0, s15
    s_add_u32 s16, s8, 25600
    buffer_load_dwordx4 v3, s[24:27], s16 offen lds
    s_add_u32 s15, s13, 2048
    s_mov_b32 m0, s15
    s_add_u32 s16, s8, 26624
    buffer_load_dwordx4 v3, s[24:27], s16 offen lds
    s_add_u32 s15, s13, 3072
    s_mov_b32 m0, s15
    s_add_u32 s16, s8, 27648
    buffer_load_dwordx4 v3, s[24:27], s16 offen lds
    s_add_u32 s15, s14, 0
    s_mov_b32 m0, s15
    s_add_u32 s16, s9, 147456
    buffer_load_dwordx4 v3, s[24:27], s16 offen lds
    s_add_u32 s15, s14, 1024
    s_mov_b32 m0, s15
    s_add_u32 s16, s9, 148480
    buffer_load_dwordx4 v3, s[24:27], s16 offen lds
    s_add_u32 s15, s14, 2048
    s_mov_b32 m0, s15
    s_add_u32 s16, s9, 149504
    buffer_load_dwordx4 v3, s[24:27], s16 offen lds
    s_add_u32 s15, s14, 3072
    s_mov_b32 m0, s15
    s_add_u32 s16, s9, 150528
    buffer_load_dwordx4 v3, s[24:27], s16 offen lds
    s_add_u32 s15, s14, 4096
    s_mov_b32 m0, s15
    s_add_u32 s16, s9, 151552
    buffer_load_dwordx4 v3, s[24:27], s16 offen lds
    s_add_u32 s15, s14, 5120
    s_mov_b32 m0, s15
    s_add_u32 s16, s9, 152576
    buffer_load_dwordx4 v3, s[24:27], s16 offen lds
    s_waitcnt vmcnt(10)
    s_barrier
    ds_read_b128 v[8:11], v4 offset:40960
    ds_read_b128 v[12:15], v5 offset:40960
    ds_read_b128 v[16:19], v5 offset:41984
    ds_read_b128 v[20:23], v5 offset:43008
    ds_read_b128 v[24:27], v5 offset:44032
    ds_read_b128 v[28:31], v5 offset:45056
    ds_read_b128 v[32:35], v5 offset:46080
    s_waitcnt lgkmcnt(0)
    v_mfma_f32_32x32x16_bf16 v[64:79], v[8:11], v[12:15], v[64:79]
    v_mfma_f32_32x32x16_bf16 v[80:95], v[8:11], v[16:19], v[80:95]
    v_mfma_f32_32x32x16_bf16 v[96:111], v[8:11], v[20:23], v[96:111]
    v_mfma_f32_32x32x16_bf16 v[112:127], v[8:11], v[24:27], v[112:127]
    v_mfma_f32_32x32x16_bf16 v[128:143], v[8:11], v[28:31], v[128:143]
    v_mfma_f32_32x32x16_bf16 v[144:159], v[8:11], v[32:35], v[144:159]
    ds_read_b128 v[36:39], v4 offset:41984
    ds_read_b128 v[40:43], v5 offset:47104
    ds_read_b128 v[44:47], v5 offset:48128
    ds_read_b128 v[48:51], v5 offset:49152
    ds_read_b128 v[52:55], v5 offset:50176
    ds_read_b128 v[56:59], v5 offset:51200
    ds_read_b128 v[60:63], v5 offset:52224
    s_waitcnt lgkmcnt(0)
    v_mfma_f32_32x32x16_bf16 v[64:79], v[36:39], v[40:43], v[64:79]
    v_mfma_f32_32x32x16_bf16 v[80:95], v[36:39], v[44:47], v[80:95]
    v_mfma_f32_32x32x16_bf16 v[96:111], v[36:39], v[48:51], v[96:111]
    v_mfma_f32_32x32x16_bf16 v[112:127], v[36:39], v[52:55], v[112:127]
    v_mfma_f32_32x32x16_bf16 v[128:143], v[36:39], v[56:59], v[128:143]
    v_mfma_f32_32x32x16_bf16 v[144:159], v[36:39], v[60:63], v[144:159]
    ds_read_b128 v[8:11], v4 offset:43008
    ds_read_b128 v[12:15], v5 offset:53248
    ds_read_b128 v[16:19], v5 offset:54272
    ds_read_b128 v[20:23], v5 offset:55296
    ds_read_b128 v[24:27], v5 offset:56320
    ds_read_b128 v[28:31], v5 offset:57344
    ds_read_b128 v[32:35], v5 offset:58368
    s_waitcnt lgkmcnt(0)
    v_mfma_f32_32x32x16_bf16 v[64:79], v[8:11], v[12:15], v[64:79]
    v_mfma_f32_32x32x16_bf16 v[80:95], v[8:11], v[16:19], v[80:95]
    v_mfma_f32_32x32x16_bf16 v[96:111], v[8:11], v[20:23], v[96:111]
    v_mfma_f32_32x32x16_bf16 v[112:127], v[8:11], v[24:27], v[112:127]
    v_mfma_f32_32x32x16_bf16 v[128:143], v[8:11], v[28:31], v[128:143]
    v_mfma_f32_32x32x16_bf16 v[144:159], v[8:11], v[32:35], v[144:159]
    ds_read_b128 v[36:39], v4 offset:44032
    ds_read_b128 v[40:43], v5 offset:59392
    ds_read_b128 v[44:47], v5 offset:60416
    ds_read_b128 v[48:51], v5 offset:61440
    ds_read_b128 v[52:55], v5 offset:62464
    ds_read_b128 v[56:59], v5 offset:63488
    ds_read_b128 v[60:63], v5 offset:64512
    s_waitcnt lgkmcnt(0)
    v_mfma_f32_32x32x16_bf16 v[64:79], v[36:39], v[40:43], v[64:79]
    v_mfma_f32_32x32x16_bf16 v[80:95], v[36:39], v[44:47], v[80:95]
    v_mfma_f32_32x32x16_bf16 v[96:111], v[36:39], v[48:51], v[96:111]
    v_mfma_f32_32x32x16_bf16 v[112:127], v[36:39], v[52:55], v[112:127]
    v_mfma_f32_32x32x16_bf16 v[128:143], v[36:39], v[56:59], v[128:143]
    v_mfma_f32_32x32x16_bf16 v[144:159], v[36:39], v[60:63], v[144:159]
    s_barrier
    s_add_u32 s15, s13, 40960
    s_mov_b32 m0, s15
    s_add_u32 s16, s8, 28672
    buffer_load_dwordx4 v3, s[24:27], s16 offen lds
    s_add_u32 s15, s13, 41984
    s_mov_b32 m0, s15
    s_add_u32 s16, s8, 29696
    buffer_load_dwordx4 v3, s[24:27], s16 offen lds
    s_add_u32 s15, s13, 43008
    s_mov_b32 m0, s15
    s_add_u32 s16, s8, 30720
    buffer_load_dwordx4 v3, s[24:27], s16 offen lds
    s_add_u32 s15, s13, 44032
    s_mov_b32 m0, s15
    s_add_u32 s16, s8, 31744
    buffer_load_dwordx4 v3, s[24:27], s16 offen lds
    s_add_u32 s15, s14, 40960
    s_mov_b32 m0, s15
    s_add_u32 s16, s9, 172032
    buffer_load_dwordx4 v3, s[24:27], s16 offen lds
    s_add_u32 s15, s14, 41984
    s_mov_b32 m0, s15
    s_add_u32 s16, s9, 173056
    buffer_load_dwordx4 v3, s[24:27], s16 offen lds
    s_add_u32 s15, s14, 43008
    s_mov_b32 m0, s15
    s_add_u32 s16, s9, 174080
    buffer_load_dwordx4 v3, s[24:27], s16 offen lds
    s_add_u32 s15, s14, 44032
    s_mov_b32 m0, s15
    s_add_u32 s16, s9, 175104
    buffer_load_dwordx4 v3, s[24:27], s16 offen lds
    s_add_u32 s15, s14, 45056
    s_mov_b32 m0, s15
    s_add_u32 s16, s9, 176128
    buffer_load_dwordx4 v3, s[24:27], s16 offen lds
    s_add_u32 s15, s14, 46080
    s_mov_b32 m0, s15
    s_add_u32 s16, s9, 177152
    buffer_load_dwordx4 v3, s[24:27], s16 offen lds
    s_waitcnt vmcnt(10)
    s_barrier
    ds_read_b128 v[8:11], v4 offset:0
    ds_read_b128 v[12:15], v5 offset:0
    ds_read_b128 v[16:19], v5 offset:1024
    ds_read_b128 v[20:23], v5 offset:2048
    ds_read_b128 v[24:27], v5 offset:3072
    ds_read_b128 v[28:31], v5 offset:4096
    ds_read_b128 v[32:35], v5 offset:5120
    s_waitcnt lgkmcnt(0)
    v_mfma_f32_32x32x16_bf16 v[64:79], v[8:11], v[12:15], v[64:79]
    v_mfma_f32_32x32x16_bf16 v[80:95], v[8:11], v[16:19], v[80:95]
    v_mfma_f32_32x32x16_bf16 v[96:111], v[8:11], v[20:23], v[96:111]
    v_mfma_f32_32x32x16_bf16 v[112:127], v[8:11], v[24:27], v[112:127]
    v_mfma_f32_32x32x16_bf16 v[128:143], v[8:11], v[28:31], v[128:143]
    v_mfma_f32_32x32x16_bf16 v[144:159], v[8:11], v[32:35], v[144:159]
    ds_read_b128 v[36:39], v4 offset:1024
    ds_read_b128 v[40:43], v5 offset:6144
    ds_read_b128 v[44:47], v5 offset:7168
    ds_read_b128 v[48:51], v5 offset:8192
    ds_read_b128 v[52:55], v5 offset:9216
    ds_read_b128 v[56:59], v5 offset:10240
    ds_read_b128 v[60:63], v5 offset:11264
    s_waitcnt lgkmcnt(0)
    v_mfma_f32_32x32x16_bf16 v[64:79], v[36:39], v[40:43], v[64:79]
    v_mfma_f32_32x32x16_bf16 v[80:95], v[36:39], v[44:47], v[80:95]
    v_mfma_f32_32x32x16_bf16 v[96:111], v[36:39], v[48:51], v[96:111]
    v_mfma_f32_32x32x16_bf16 v[112:127], v[36:39], v[52:55], v[112:127]
    v_mfma_f32_32x32x16_bf16 v[128:143], v[36:39], v[56:59], v[128:143]
    v_mfma_f32_32x32x16_bf16 v[144:159], v[36:39], v[60:63], v[144:159]
    ds_read_b128 v[8:11], v4 offset:2048
    ds_read_b128 v[12:15], v5 offset:12288
    ds_read_b128 v[16:19], v5 offset:13312
    ds_read_b128 v[20:23], v5 offset:14336
    ds_read_b128 v[24:27], v5 offset:15360
    ds_read_b128 v[28:31], v5 offset:16384
    ds_read_b128 v[32:35], v5 offset:17408
    s_waitcnt lgkmcnt(0)
    v_mfma_f32_32x32x16_bf16 v[64:79], v[8:11], v[12:15], v[64:79]
    v_mfma_f32_32x32x16_bf16 v[80:95], v[8:11], v[16:19], v[80:95]
    v_mfma_f32_32x32x16_bf16 v[96:111], v[8:11], v[20:23], v[96:111]
    v_mfma_f32_32x32x16_bf16 v[112:127], v[8:11], v[24:27], v[112:127]
    v_mfma_f32_32x32x16_bf16 v[128:143], v[8:11], v[28:31], v[128:143]
    v_mfma_f32_32x32x16_bf16 v[144:159], v[8:11], v[32:35], v[144:159]
    ds_read_b128 v[36:39], v4 offset:3072
    ds_read_b128 v[40:43], v5 offset:18432
    ds_read_b128 v[44:47], v5 offset:19456
    ds_read_b128 v[48:51], v5 offset:20480
    ds_read_b128 v[52:55], v5 offset:21504
    ds_read_b128 v[56:59], v5 offset:22528
    ds_read_b128 v[60:63], v5 offset:23552
    s_waitcnt lgkmcnt(0)
    v_mfma_f32_32x32x16_bf16 v[64:79], v[36:39], v[40:43], v[64:79]
    v_mfma_f32_32x32x16_bf16 v[80:95], v[36:39], v[44:47], v[80:95]
    v_mfma_f32_32x32x16_bf16 v[96:111], v[36:39], v[48:51], v[96:111]
    v_mfma_f32_32x32x16_bf16 v[112:127], v[36:39], v[52:55], v[112:127]
    v_mfma_f32_32x32x16_bf16 v[128:143], v[36:39], v[56:59], v[128:143]
    v_mfma_f32_32x32x16_bf16 v[144:159], v[36:39], v[60:63], v[144:159]
    s_barrier
    s_waitcnt vmcnt(0)
    s_barrier
    ds_read_b128 v[8:11], v4 offset:40960
    ds_read_b128 v[12:15], v5 offset:40960
    ds_read_b128 v[16:19], v5 offset:41984
    ds_read_b128 v[20:23], v5 offset:43008
    ds_read_b128 v[24:27], v5 offset:44032
    ds_read_b128 v[28:31], v5 offset:45056
    ds_read_b128 v[32:35], v5 offset:46080
    s_waitcnt lgkmcnt(0)
    v_mfma_f32_32x32x16_bf16 v[64:79], v[8:11], v[12:15], v[64:79]
    v_mfma_f32_32x32x16_bf16 v[80:95], v[8:11], v[16:19], v[80:95]
    v_mfma_f32_32x32x16_bf16 v[96:111], v[8:11], v[20:23], v[96:111]
    v_mfma_f32_32x32x16_bf16 v[112:127], v[8:11], v[24:27], v[112:127]
    v_mfma_f32_32x32x16_bf16 v[128:143], v[8:11], v[28:31], v[128:143]
    v_mfma_f32_32x32x16_bf16 v[144:159], v[8:11], v[32:35], v[144:159]
    ds_read_b128 v[36:39], v4 offset:41984
    ds_read_b128 v[40:43], v5 offset:47104
    ds_read_b128 v[44:47], v5 offset:48128
    ds_read_b128 v[48:51], v5 offset:49152
    ds_read_b128 v[52:55], v5 offset:50176
    ds_read_b128 v[56:59], v5 offset:51200
    ds_read_b128 v[60:63], v5 offset:52224
    s_waitcnt lgkmcnt(0)
    v_mfma_f32_32x32x16_bf16 v[64:79], v[36:39], v[40:43], v[64:79]
    v_mfma_f32_32x32x16_bf16 v[80:95], v[36:39], v[44:47], v[80:95]
    v_mfma_f32_32x32x16_bf16 v[96:111], v[36:39], v[48:51], v[96:111]
    v_mfma_f32_32x32x16_bf16 v[112:127], v[36:39], v[52:55], v[112:127]
    v_mfma_f32_32x32x16_bf16 v[128:143], v[36:39], v[56:59], v[128:143]
    v_mfma_f32_32x32x16_bf16 v[144:159], v[36:39], v[60:63], v[144:159]
    ds_read_b128 v[8:11], v4 offset:43008
    ds_read_b128 v[12:15], v5 offset:53248
    ds_read_b128 v[16:19], v5 offset:54272
    ds_read_b128 v[20:23], v5 offset:55296
    ds_read_b128 v[24:27], v5 offset:56320
    ds_read_b128 v[28:31], v5 offset:57344
    ds_read_b128 v[32:35], v5 offset:58368
    s_waitcnt lgkmcnt(0)
    v_mfma_f32_32x32x16_bf16 v[64:79], v[8:11], v[12:15], v[64:79]
    v_mfma_f32_32x32x16_bf16 v[80:95], v[8:11], v[16:19], v[80:95]
    v_mfma_f32_32x32x16_bf16 v[96:111], v[8:11], v[20:23], v[96:111]
    v_mfma_f32_32x32x16_bf16 v[112:127], v[8:11], v[24:27], v[112:127]
    v_mfma_f32_32x32x16_bf16 v[128:143], v[8:11], v[28:31], v[128:143]
    v_mfma_f32_32x32x16_bf16 v[144:159], v[8:11], v[32:35], v[144:159]
    ds_read_b128 v[36:39], v4 offset:44032
    ds_read_b128 v[40:43], v5 offset:59392
    ds_read_b128 v[44:47], v5 offset:60416
    ds_read_b128 v[48:51], v5 offset:61440
    ds_read_b128 v[52:55], v5 offset:62464
    ds_read_b128 v[56:59], v5 offset:63488
    ds_read_b128 v[60:63], v5 offset:64512
    s_waitcnt lgkmcnt(0)
    v_mfma_f32_32x32x16_bf16 v[64:79], v[36:39], v[40:43], v[64:79]
    v_mfma_f32_32x32x16_bf16 v[80:95], v[36:39], v[44:47], v[80:95]
    v_mfma_f32_32x32x16_bf16 v[96:111], v[36:39], v[48:51], v[96:111]
    v_mfma_f32_32x32x16_bf16 v[112:127], v[36:39], v[52:55], v[112:127]
    v_mfma_f32_32x32x16_bf16 v[128:143], v[36:39], v[56:59], v[128:143]
    v_mfma_f32_32x32x16_bf16 v[144:159], v[36:39], v[60:63], v[144:159]
    s_barrier
    s_nop 15
    s_nop 7
    s_mul_i32 s13, s6, 6656
    v_and_b32 v6, 31, v1
    v_lshrrev_b32 v7, 5, v1
    v_mul_u32_u24 v7, 832, v7
    v_lshl_add_u32 v7, v6, 1, v7
    v_add_u32 v7, s13, v7
    s_mov_b32 s20, 0xc0135761
    v_cvt_pk_bf16_f32 v8, v64, v112
    v_lshlrev_b32 v9, 16, v8
    v_and_b32 v10, 0xffff0000, v8
    v_mul_f32 v11, v9, v9
    v_mul_f32 v11, 0x3d372713, v11
    v_fma_f32 v11, v11, v9, v9
    v_mul_f32 v11, s20, v11
    v_exp_f32 v11, v11
    s_nop 0
    v_add_f32 v11, 1.0, v11
    v_rcp_f32 v11, v11
    s_nop 0
    v_mul_f32 v11, v9, v11
    v_cvt_pk_bf16_f32 v11, v11, v11
    v_lshlrev_b32 v11, 16, v11
    v_mul_f32 v11, v11, v10
    v_cvt_pk_bf16_f32 v11, v11, v11
    ds_write_b16 v7, v11 offset:0
    v_cvt_pk_bf16_f32 v8, v65, v113
    v_lshlrev_b32 v9, 16, v8
    v_and_b32 v10, 0xffff0000, v8
    v_mul_f32 v11, v9, v9
    v_mul_f32 v11, 0x3d372713, v11
    v_fma_f32 v11, v11, v9, v9
    v_mul_f32 v11, s20, v11
    v_exp_f32 v11, v11
    s_nop 0
    v_add_f32 v11, 1.0, v11
    v_rcp_f32 v11, v11
    s_nop 0
    v_mul_f32 v11, v9, v11
    v_cvt_pk_bf16_f32 v11, v11, v11
    v_lshlrev_b32 v11, 16, v11
    v_mul_f32 v11, v11, v10
    v_cvt_pk_bf16_f32 v11, v11, v11
    ds_write_b16 v7, v11 offset:208
    v_cvt_pk_bf16_f32 v8, v66, v114
    v_lshlrev_b32 v9, 16, v8
    v_and_b32 v10, 0xffff0000, v8
    v_mul_f32 v11, v9, v9
    v_mul_f32 v11, 0x3d372713, v11
    v_fma_f32 v11, v11, v9, v9
    v_mul_f32 v11, s20, v11
    v_exp_f32 v11, v11
    s_nop 0
    v_add_f32 v11, 1.0, v11
    v_rcp_f32 v11, v11
    s_nop 0
    v_mul_f32 v11, v9, v11
    v_cvt_pk_bf16_f32 v11, v11, v11
    v_lshlrev_b32 v11, 16, v11
    v_mul_f32 v11, v11, v10
    v_cvt_pk_bf16_f32 v11, v11, v11
    ds_write_b16 v7, v11 offset:416
    v_cvt_pk_bf16_f32 v8, v67, v115
    v_lshlrev_b32 v9, 16, v8
    v_and_b32 v10, 0xffff0000, v8
    v_mul_f32 v11, v9, v9
    v_mul_f32 v11, 0x3d372713, v11
    v_fma_f32 v11, v11, v9, v9
    v_mul_f32 v11, s20, v11
    v_exp_f32 v11, v11
    s_nop 0
    v_add_f32 v11, 1.0, v11
    v_rcp_f32 v11, v11
    s_nop 0
    v_mul_f32 v11, v9, v11
    v_cvt_pk_bf16_f32 v11, v11, v11
    v_lshlrev_b32 v11, 16, v11
    v_mul_f32 v11, v11, v10
    v_cvt_pk_bf16_f32 v11, v11, v11
    ds_write_b16 v7, v11 offset:624
    v_cvt_pk_bf16_f32 v8, v68, v116
    v_lshlrev_b32 v9, 16, v8
    v_and_b32 v10, 0xffff0000, v8
    v_mul_f32 v11, v9, v9
    v_mul_f32 v11, 0x3d372713, v11
    v_fma_f32 v11, v11, v9, v9
    v_mul_f32 v11, s20, v11
    v_exp_f32 v11, v11
    s_nop 0
    v_add_f32 v11, 1.0, v11
    v_rcp_f32 v11, v11
    s_nop 0
    v_mul_f32 v11, v9, v11
    v_cvt_pk_bf16_f32 v11, v11, v11
    v_lshlrev_b32 v11, 16, v11
    v_mul_f32 v11, v11, v10
    v_cvt_pk_bf16_f32 v11, v11, v11
    ds_write_b16 v7, v11 offset:1664
    v_cvt_pk_bf16_f32 v8, v69, v117
    v_lshlrev_b32 v9, 16, v8
    v_and_b32 v10, 0xffff0000, v8
    v_mul_f32 v11, v9, v9
    v_mul_f32 v11, 0x3d372713, v11
    v_fma_f32 v11, v11, v9, v9
    v_mul_f32 v11, s20, v11
    v_exp_f32 v11, v11
    s_nop 0
    v_add_f32 v11, 1.0, v11
    v_rcp_f32 v11, v11
    s_nop 0
    v_mul_f32 v11, v9, v11
    v_cvt_pk_bf16_f32 v11, v11, v11
    v_lshlrev_b32 v11, 16, v11
    v_mul_f32 v11, v11, v10
    v_cvt_pk_bf16_f32 v11, v11, v11
    ds_write_b16 v7, v11 offset:1872
    v_cvt_pk_bf16_f32 v8, v70, v118
    v_lshlrev_b32 v9, 16, v8
    v_and_b32 v10, 0xffff0000, v8
    v_mul_f32 v11, v9, v9
    v_mul_f32 v11, 0x3d372713, v11
    v_fma_f32 v11, v11, v9, v9
    v_mul_f32 v11, s20, v11
    v_exp_f32 v11, v11
    s_nop 0
    v_add_f32 v11, 1.0, v11
    v_rcp_f32 v11, v11
    s_nop 0
    v_mul_f32 v11, v9, v11
    v_cvt_pk_bf16_f32 v11, v11, v11
    v_lshlrev_b32 v11, 16, v11
    v_mul_f32 v11, v11, v10
    v_cvt_pk_bf16_f32 v11, v11, v11
    ds_write_b16 v7, v11 offset:2080
    v_cvt_pk_bf16_f32 v8, v71, v119
    v_lshlrev_b32 v9, 16, v8
    v_and_b32 v10, 0xffff0000, v8
    v_mul_f32 v11, v9, v9
    v_mul_f32 v11, 0x3d372713, v11
    v_fma_f32 v11, v11, v9, v9
    v_mul_f32 v11, s20, v11
    v_exp_f32 v11, v11
    s_nop 0
    v_add_f32 v11, 1.0, v11
    v_rcp_f32 v11, v11
    s_nop 0
    v_mul_f32 v11, v9, v11
    v_cvt_pk_bf16_f32 v11, v11, v11
    v_lshlrev_b32 v11, 16, v11
    v_mul_f32 v11, v11, v10
    v_cvt_pk_bf16_f32 v11, v11, v11
    ds_write_b16 v7, v11 offset:2288
    v_cvt_pk_bf16_f32 v8, v72, v120
    v_lshlrev_b32 v9, 16, v8
    v_and_b32 v10, 0xffff0000, v8
    v_mul_f32 v11, v9, v9
    v_mul_f32 v11, 0x3d372713, v11
    v_fma_f32 v11, v11, v9, v9
    v_mul_f32 v11, s20, v11
    v_exp_f32 v11, v11
    s_nop 0
    v_add_f32 v11, 1.0, v11
    v_rcp_f32 v11, v11
    s_nop 0
    v_mul_f32 v11, v9, v11
    v_cvt_pk_bf16_f32 v11, v11, v11
    v_lshlrev_b32 v11, 16, v11
    v_mul_f32 v11, v11, v10
    v_cvt_pk_bf16_f32 v11, v11, v11
    ds_write_b16 v7, v11 offset:3328
    v_cvt_pk_bf16_f32 v8, v73, v121
    v_lshlrev_b32 v9, 16, v8
    v_and_b32 v10, 0xffff0000, v8
    v_mul_f32 v11, v9, v9
    v_mul_f32 v11, 0x3d372713, v11
    v_fma_f32 v11, v11, v9, v9
    v_mul_f32 v11, s20, v11
    v_exp_f32 v11, v11
    s_nop 0
    v_add_f32 v11, 1.0, v11
    v_rcp_f32 v11, v11
    s_nop 0
    v_mul_f32 v11, v9, v11
    v_cvt_pk_bf16_f32 v11, v11, v11
    v_lshlrev_b32 v11, 16, v11
    v_mul_f32 v11, v11, v10
    v_cvt_pk_bf16_f32 v11, v11, v11
    ds_write_b16 v7, v11 offset:3536
    v_cvt_pk_bf16_f32 v8, v74, v122
    v_lshlrev_b32 v9, 16, v8
    v_and_b32 v10, 0xffff0000, v8
    v_mul_f32 v11, v9, v9
    v_mul_f32 v11, 0x3d372713, v11
    v_fma_f32 v11, v11, v9, v9
    v_mul_f32 v11, s20, v11
    v_exp_f32 v11, v11
    s_nop 0
    v_add_f32 v11, 1.0, v11
    v_rcp_f32 v11, v11
    s_nop 0
    v_mul_f32 v11, v9, v11
    v_cvt_pk_bf16_f32 v11, v11, v11
    v_lshlrev_b32 v11, 16, v11
    v_mul_f32 v11, v11, v10
    v_cvt_pk_bf16_f32 v11, v11, v11
    ds_write_b16 v7, v11 offset:3744
    v_cvt_pk_bf16_f32 v8, v75, v123
    v_lshlrev_b32 v9, 16, v8
    v_and_b32 v10, 0xffff0000, v8
    v_mul_f32 v11, v9, v9
    v_mul_f32 v11, 0x3d372713, v11
    v_fma_f32 v11, v11, v9, v9
    v_mul_f32 v11, s20, v11
    v_exp_f32 v11, v11
    s_nop 0
    v_add_f32 v11, 1.0, v11
    v_rcp_f32 v11, v11
    s_nop 0
    v_mul_f32 v11, v9, v11
    v_cvt_pk_bf16_f32 v11, v11, v11
    v_lshlrev_b32 v11, 16, v11
    v_mul_f32 v11, v11, v10
    v_cvt_pk_bf16_f32 v11, v11, v11
    ds_write_b16 v7, v11 offset:3952
    v_cvt_pk_bf16_f32 v8, v76, v124
    v_lshlrev_b32 v9, 16, v8
    v_and_b32 v10, 0xffff0000, v8
    v_mul_f32 v11, v9, v9
    v_mul_f32 v11, 0x3d372713, v11
    v_fma_f32 v11, v11, v9, v9
    v_mul_f32 v11, s20, v11
    v_exp_f32 v11, v11
    s_nop 0
    v_add_f32 v11, 1.0, v11
    v_rcp_f32 v11, v11
    s_nop 0
    v_mul_f32 v11, v9, v11
    v_cvt_pk_bf16_f32 v11, v11, v11
    v_lshlrev_b32 v11, 16, v11
    v_mul_f32 v11, v11, v10
    v_cvt_pk_bf16_f32 v11, v11, v11
    ds_write_b16 v7, v11 offset:4992
    v_cvt_pk_bf16_f32 v8, v77, v125
    v_lshlrev_b32 v9, 16, v8
    v_and_b32 v10, 0xffff0000, v8
    v_mul_f32 v11, v9, v9
    v_mul_f32 v11, 0x3d372713, v11
    v_fma_f32 v11, v11, v9, v9
    v_mul_f32 v11, s20, v11
    v_exp_f32 v11, v11
    s_nop 0
    v_add_f32 v11, 1.0, v11
    v_rcp_f32 v11, v11
    s_nop 0
    v_mul_f32 v11, v9, v11
    v_cvt_pk_bf16_f32 v11, v11, v11
    v_lshlrev_b32 v11, 16, v11
    v_mul_f32 v11, v11, v10
    v_cvt_pk_bf16_f32 v11, v11, v11
    ds_write_b16 v7, v11 offset:5200
    v_cvt_pk_bf16_f32 v8, v78, v126
    v_lshlrev_b32 v9, 16, v8
    v_and_b32 v10, 0xffff0000, v8
    v_mul_f32 v11, v9, v9
    v_mul_f32 v11, 0x3d372713, v11
    v_fma_f32 v11, v11, v9, v9
    v_mul_f32 v11, s20, v11
    v_exp_f32 v11, v11
    s_nop 0
    v_add_f32 v11, 1.0, v11
    v_rcp_f32 v11, v11
    s_nop 0
    v_mul_f32 v11, v9, v11
    v_cvt_pk_bf16_f32 v11, v11, v11
    v_lshlrev_b32 v11, 16, v11
    v_mul_f32 v11, v11, v10
    v_cvt_pk_bf16_f32 v11, v11, v11
    ds_write_b16 v7, v11 offset:5408
    v_cvt_pk_bf16_f32 v8, v79, v127
    v_lshlrev_b32 v9, 16, v8
    v_and_b32 v10, 0xffff0000, v8
    v_mul_f32 v11, v9, v9
    v_mul_f32 v11, 0x3d372713, v11
    v_fma_f32 v11, v11, v9, v9
    v_mul_f32 v11, s20, v11
    v_exp_f32 v11, v11
    s_nop 0
    v_add_f32 v11, 1.0, v11
    v_rcp_f32 v11, v11
    s_nop 0
    v_mul_f32 v11, v9, v11
    v_cvt_pk_bf16_f32 v11, v11, v11
    v_lshlrev_b32 v11, 16, v11
    v_mul_f32 v11, v11, v10
    v_cvt_pk_bf16_f32 v11, v11, v11
    ds_write_b16 v7, v11 offset:5616
    v_cvt_pk_bf16_f32 v8, v80, v128
    v_lshlrev_b32 v9, 16, v8
    v_and_b32 v10, 0xffff0000, v8
    v_mul_f32 v11, v9, v9
    v_mul_f32 v11, 0x3d372713, v11
    v_fma_f32 v11, v11, v9, v9
    v_mul_f32 v11, s20, v11
    v_exp_f32 v11, v11
    s_nop 0
    v_add_f32 v11, 1.0, v11
    v_rcp_f32 v11, v11
    s_nop 0
    v_mul_f32 v11, v9, v11
    v_cvt_pk_bf16_f32 v11, v11, v11
    v_lshlrev_b32 v11, 16, v11
    v_mul_f32 v11, v11, v10
    v_cvt_pk_bf16_f32 v11, v11, v11
    ds_write_b16 v7, v11 offset:64
    v_cvt_pk_bf16_f32 v8, v81, v129
    v_lshlrev_b32 v9, 16, v8
    v_and_b32 v10, 0xffff0000, v8
    v_mul_f32 v11, v9, v9
    v_mul_f32 v11, 0x3d372713, v11
    v_fma_f32 v11, v11, v9, v9
    v_mul_f32 v11, s20, v11
    v_exp_f32 v11, v11
    s_nop 0
    v_add_f32 v11, 1.0, v11
    v_rcp_f32 v11, v11
    s_nop 0
    v_mul_f32 v11, v9, v11
    v_cvt_pk_bf16_f32 v11, v11, v11
    v_lshlrev_b32 v11, 16, v11
    v_mul_f32 v11, v11, v10
    v_cvt_pk_bf16_f32 v11, v11, v11
    ds_write_b16 v7, v11 offset:272
    v_cvt_pk_bf16_f32 v8, v82, v130
    v_lshlrev_b32 v9, 16, v8
    v_and_b32 v10, 0xffff0000, v8
    v_mul_f32 v11, v9, v9
    v_mul_f32 v11, 0x3d372713, v11
    v_fma_f32 v11, v11, v9, v9
    v_mul_f32 v11, s20, v11
    v_exp_f32 v11, v11
    s_nop 0
    v_add_f32 v11, 1.0, v11
    v_rcp_f32 v11, v11
    s_nop 0
    v_mul_f32 v11, v9, v11
    v_cvt_pk_bf16_f32 v11, v11, v11
    v_lshlrev_b32 v11, 16, v11
    v_mul_f32 v11, v11, v10
    v_cvt_pk_bf16_f32 v11, v11, v11
    ds_write_b16 v7, v11 offset:480
    v_cvt_pk_bf16_f32 v8, v83, v131
    v_lshlrev_b32 v9, 16, v8
    v_and_b32 v10, 0xffff0000, v8
    v_mul_f32 v11, v9, v9
    v_mul_f32 v11, 0x3d372713, v11
    v_fma_f32 v11, v11, v9, v9
    v_mul_f32 v11, s20, v11
    v_exp_f32 v11, v11
    s_nop 0
    v_add_f32 v11, 1.0, v11
    v_rcp_f32 v11, v11
    s_nop 0
    v_mul_f32 v11, v9, v11
    v_cvt_pk_bf16_f32 v11, v11, v11
    v_lshlrev_b32 v11, 16, v11
    v_mul_f32 v11, v11, v10
    v_cvt_pk_bf16_f32 v11, v11, v11
    ds_write_b16 v7, v11 offset:688
    v_cvt_pk_bf16_f32 v8, v84, v132
    v_lshlrev_b32 v9, 16, v8
    v_and_b32 v10, 0xffff0000, v8
    v_mul_f32 v11, v9, v9
    v_mul_f32 v11, 0x3d372713, v11
    v_fma_f32 v11, v11, v9, v9
    v_mul_f32 v11, s20, v11
    v_exp_f32 v11, v11
    s_nop 0
    v_add_f32 v11, 1.0, v11
    v_rcp_f32 v11, v11
    s_nop 0
    v_mul_f32 v11, v9, v11
    v_cvt_pk_bf16_f32 v11, v11, v11
    v_lshlrev_b32 v11, 16, v11
    v_mul_f32 v11, v11, v10
    v_cvt_pk_bf16_f32 v11, v11, v11
    ds_write_b16 v7, v11 offset:1728
    v_cvt_pk_bf16_f32 v8, v85, v133
    v_lshlrev_b32 v9, 16, v8
    v_and_b32 v10, 0xffff0000, v8
    v_mul_f32 v11, v9, v9
    v_mul_f32 v11, 0x3d372713, v11
    v_fma_f32 v11, v11, v9, v9
    v_mul_f32 v11, s20, v11
    v_exp_f32 v11, v11
    s_nop 0
    v_add_f32 v11, 1.0, v11
    v_rcp_f32 v11, v11
    s_nop 0
    v_mul_f32 v11, v9, v11
    v_cvt_pk_bf16_f32 v11, v11, v11
    v_lshlrev_b32 v11, 16, v11
    v_mul_f32 v11, v11, v10
    v_cvt_pk_bf16_f32 v11, v11, v11
    ds_write_b16 v7, v11 offset:1936
    v_cvt_pk_bf16_f32 v8, v86, v134
    v_lshlrev_b32 v9, 16, v8
    v_and_b32 v10, 0xffff0000, v8
    v_mul_f32 v11, v9, v9
    v_mul_f32 v11, 0x3d372713, v11
    v_fma_f32 v11, v11, v9, v9
    v_mul_f32 v11, s20, v11
    v_exp_f32 v11, v11
    s_nop 0
    v_add_f32 v11, 1.0, v11
    v_rcp_f32 v11, v11
    s_nop 0
    v_mul_f32 v11, v9, v11
    v_cvt_pk_bf16_f32 v11, v11, v11
    v_lshlrev_b32 v11, 16, v11
    v_mul_f32 v11, v11, v10
    v_cvt_pk_bf16_f32 v11, v11, v11
    ds_write_b16 v7, v11 offset:2144
    v_cvt_pk_bf16_f32 v8, v87, v135
    v_lshlrev_b32 v9, 16, v8
    v_and_b32 v10, 0xffff0000, v8
    v_mul_f32 v11, v9, v9
    v_mul_f32 v11, 0x3d372713, v11
    v_fma_f32 v11, v11, v9, v9
    v_mul_f32 v11, s20, v11
    v_exp_f32 v11, v11
    s_nop 0
    v_add_f32 v11, 1.0, v11
    v_rcp_f32 v11, v11
    s_nop 0
    v_mul_f32 v11, v9, v11
    v_cvt_pk_bf16_f32 v11, v11, v11
    v_lshlrev_b32 v11, 16, v11
    v_mul_f32 v11, v11, v10
    v_cvt_pk_bf16_f32 v11, v11, v11
    ds_write_b16 v7, v11 offset:2352
    v_cvt_pk_bf16_f32 v8, v88, v136
    v_lshlrev_b32 v9, 16, v8
    v_and_b32 v10, 0xffff0000, v8
    v_mul_f32 v11, v9, v9
    v_mul_f32 v11, 0x3d372713, v11
    v_fma_f32 v11, v11, v9, v9
    v_mul_f32 v11, s20, v11
    v_exp_f32 v11, v11
    s_nop 0
    v_add_f32 v11, 1.0, v11
    v_rcp_f32 v11, v11
    s_nop 0
    v_mul_f32 v11, v9, v11
    v_cvt_pk_bf16_f32 v11, v11, v11
    v_lshlrev_b32 v11, 16, v11
    v_mul_f32 v11, v11, v10
    v_cvt_pk_bf16_f32 v11, v11, v11
    ds_write_b16 v7, v11 offset:3392
    v_cvt_pk_bf16_f32 v8, v89, v137
    v_lshlrev_b32 v9, 16, v8
    v_and_b32 v10, 0xffff0000, v8
    v_mul_f32 v11, v9, v9
    v_mul_f32 v11, 0x3d372713, v11
    v_fma_f32 v11, v11, v9, v9
    v_mul_f32 v11, s20, v11
    v_exp_f32 v11, v11
    s_nop 0
    v_add_f32 v11, 1.0, v11
    v_rcp_f32 v11, v11
    s_nop 0
    v_mul_f32 v11, v9, v11
    v_cvt_pk_bf16_f32 v11, v11, v11
    v_lshlrev_b32 v11, 16, v11
    v_mul_f32 v11, v11, v10
    v_cvt_pk_bf16_f32 v11, v11, v11
    ds_write_b16 v7, v11 offset:3600
    v_cvt_pk_bf16_f32 v8, v90, v138
    v_lshlrev_b32 v9, 16, v8
    v_and_b32 v10, 0xffff0000, v8
    v_mul_f32 v11, v9, v9
    v_mul_f32 v11, 0x3d372713, v11
    v_fma_f32 v11, v11, v9, v9
    v_mul_f32 v11, s20, v11
    v_exp_f32 v11, v11
    s_nop 0
    v_add_f32 v11, 1.0, v11
    v_rcp_f32 v11, v11
    s_nop 0
    v_mul_f32 v11, v9, v11
    v_cvt_pk_bf16_f32 v11, v11, v11
    v_lshlrev_b32 v11, 16, v11
    v_mul_f32 v11, v11, v10
    v_cvt_pk_bf16_f32 v11, v11, v11
    ds_write_b16 v7, v11 offset:3808
    v_cvt_pk_bf16_f32 v8, v91, v139
    v_lshlrev_b32 v9, 16, v8
    v_and_b32 v10, 0xffff0000, v8
    v_mul_f32 v11, v9, v9
    v_mul_f32 v11, 0x3d372713, v11
    v_fma_f32 v11, v11, v9, v9
    v_mul_f32 v11, s20, v11
    v_exp_f32 v11, v11
    s_nop 0
    v_add_f32 v11, 1.0, v11
    v_rcp_f32 v11, v11
    s_nop 0
    v_mul_f32 v11, v9, v11
    v_cvt_pk_bf16_f32 v11, v11, v11
    v_lshlrev_b32 v11, 16, v11
    v_mul_f32 v11, v11, v10
    v_cvt_pk_bf16_f32 v11, v11, v11
    ds_write_b16 v7, v11 offset:4016
    v_cvt_pk_bf16_f32 v8, v92, v140
    v_lshlrev_b32 v9, 16, v8
    v_and_b32 v10, 0xffff0000, v8
    v_mul_f32 v11, v9, v9
    v_mul_f32 v11, 0x3d372713, v11
    v_fma_f32 v11, v11, v9, v9
    v_mul_f32 v11, s20, v11
    v_exp_f32 v11, v11
    s_nop 0
    v_add_f32 v11, 1.0, v11
    v_rcp_f32 v11, v11
    s_nop 0
    v_mul_f32 v11, v9, v11
    v_cvt_pk_bf16_f32 v11, v11, v11
    v_lshlrev_b32 v11, 16, v11
    v_mul_f32 v11, v11, v10
    v_cvt_pk_bf16_f32 v11, v11, v11
    ds_write_b16 v7, v11 offset:5056
    v_cvt_pk_bf16_f32 v8, v93, v141
    v_lshlrev_b32 v9, 16, v8
    v_and_b32 v10, 0xffff0000, v8
    v_mul_f32 v11, v9, v9
    v_mul_f32 v11, 0x3d372713, v11
    v_fma_f32 v11, v11, v9, v9
    v_mul_f32 v11, s20, v11
    v_exp_f32 v11, v11
    s_nop 0
    v_add_f32 v11, 1.0, v11
    v_rcp_f32 v11, v11
    s_nop 0
    v_mul_f32 v11, v9, v11
    v_cvt_pk_bf16_f32 v11, v11, v11
    v_lshlrev_b32 v11, 16, v11
    v_mul_f32 v11, v11, v10
    v_cvt_pk_bf16_f32 v11, v11, v11
    ds_write_b16 v7, v11 offset:5264
    v_cvt_pk_bf16_f32 v8, v94, v142
    v_lshlrev_b32 v9, 16, v8
    v_and_b32 v10, 0xffff0000, v8
    v_mul_f32 v11, v9, v9
    v_mul_f32 v11, 0x3d372713, v11
    v_fma_f32 v11, v11, v9, v9
    v_mul_f32 v11, s20, v11
    v_exp_f32 v11, v11
    s_nop 0
    v_add_f32 v11, 1.0, v11
    v_rcp_f32 v11, v11
    s_nop 0
    v_mul_f32 v11, v9, v11
    v_cvt_pk_bf16_f32 v11, v11, v11
    v_lshlrev_b32 v11, 16, v11
    v_mul_f32 v11, v11, v10
    v_cvt_pk_bf16_f32 v11, v11, v11
    ds_write_b16 v7, v11 offset:5472
    v_cvt_pk_bf16_f32 v8, v95, v143
    v_lshlrev_b32 v9, 16, v8
    v_and_b32 v10, 0xffff0000, v8
    v_mul_f32 v11, v9, v9
    v_mul_f32 v11, 0x3d372713, v11
    v_fma_f32 v11, v11, v9, v9
    v_mul_f32 v11, s20, v11
    v_exp_f32 v11, v11
    s_nop 0
    v_add_f32 v11, 1.0, v11
    v_rcp_f32 v11, v11
    s_nop 0
    v_mul_f32 v11, v9, v11
    v_cvt_pk_bf16_f32 v11, v11, v11
    v_lshlrev_b32 v11, 16, v11
    v_mul_f32 v11, v11, v10
    v_cvt_pk_bf16_f32 v11, v11, v11
    ds_write_b16 v7, v11 offset:5680
    v_cvt_pk_bf16_f32 v8, v96, v144
    v_lshlrev_b32 v9, 16, v8
    v_and_b32 v10, 0xffff0000, v8
    v_mul_f32 v11, v9, v9
    v_mul_f32 v11, 0x3d372713, v11
    v_fma_f32 v11, v11, v9, v9
    v_mul_f32 v11, s20, v11
    v_exp_f32 v11, v11
    s_nop 0
    v_add_f32 v11, 1.0, v11
    v_rcp_f32 v11, v11
    s_nop 0
    v_mul_f32 v11, v9, v11
    v_cvt_pk_bf16_f32 v11, v11, v11
    v_lshlrev_b32 v11, 16, v11
    v_mul_f32 v11, v11, v10
    v_cvt_pk_bf16_f32 v11, v11, v11
    ds_write_b16 v7, v11 offset:128
    v_cvt_pk_bf16_f32 v8, v97, v145
    v_lshlrev_b32 v9, 16, v8
    v_and_b32 v10, 0xffff0000, v8
    v_mul_f32 v11, v9, v9
    v_mul_f32 v11, 0x3d372713, v11
    v_fma_f32 v11, v11, v9, v9
    v_mul_f32 v11, s20, v11
    v_exp_f32 v11, v11
    s_nop 0
    v_add_f32 v11, 1.0, v11
    v_rcp_f32 v11, v11
    s_nop 0
    v_mul_f32 v11, v9, v11
    v_cvt_pk_bf16_f32 v11, v11, v11
    v_lshlrev_b32 v11, 16, v11
    v_mul_f32 v11, v11, v10
    v_cvt_pk_bf16_f32 v11, v11, v11
    ds_write_b16 v7, v11 offset:336
    v_cvt_pk_bf16_f32 v8, v98, v146
    v_lshlrev_b32 v9, 16, v8
    v_and_b32 v10, 0xffff0000, v8
    v_mul_f32 v11, v9, v9
    v_mul_f32 v11, 0x3d372713, v11
    v_fma_f32 v11, v11, v9, v9
    v_mul_f32 v11, s20, v11
    v_exp_f32 v11, v11
    s_nop 0
    v_add_f32 v11, 1.0, v11
    v_rcp_f32 v11, v11
    s_nop 0
    v_mul_f32 v11, v9, v11
    v_cvt_pk_bf16_f32 v11, v11, v11
    v_lshlrev_b32 v11, 16, v11
    v_mul_f32 v11, v11, v10
    v_cvt_pk_bf16_f32 v11, v11, v11
    ds_write_b16 v7, v11 offset:544
    v_cvt_pk_bf16_f32 v8, v99, v147
    v_lshlrev_b32 v9, 16, v8
    v_and_b32 v10, 0xffff0000, v8
    v_mul_f32 v11, v9, v9
    v_mul_f32 v11, 0x3d372713, v11
    v_fma_f32 v11, v11, v9, v9
    v_mul_f32 v11, s20, v11
    v_exp_f32 v11, v11
    s_nop 0
    v_add_f32 v11, 1.0, v11
    v_rcp_f32 v11, v11
    s_nop 0
    v_mul_f32 v11, v9, v11
    v_cvt_pk_bf16_f32 v11, v11, v11
    v_lshlrev_b32 v11, 16, v11
    v_mul_f32 v11, v11, v10
    v_cvt_pk_bf16_f32 v11, v11, v11
    ds_write_b16 v7, v11 offset:752
    v_cvt_pk_bf16_f32 v8, v100, v148
    v_lshlrev_b32 v9, 16, v8
    v_and_b32 v10, 0xffff0000, v8
    v_mul_f32 v11, v9, v9
    v_mul_f32 v11, 0x3d372713, v11
    v_fma_f32 v11, v11, v9, v9
    v_mul_f32 v11, s20, v11
    v_exp_f32 v11, v11
    s_nop 0
    v_add_f32 v11, 1.0, v11
    v_rcp_f32 v11, v11
    s_nop 0
    v_mul_f32 v11, v9, v11
    v_cvt_pk_bf16_f32 v11, v11, v11
    v_lshlrev_b32 v11, 16, v11
    v_mul_f32 v11, v11, v10
    v_cvt_pk_bf16_f32 v11, v11, v11
    ds_write_b16 v7, v11 offset:1792
    v_cvt_pk_bf16_f32 v8, v101, v149
    v_lshlrev_b32 v9, 16, v8
    v_and_b32 v10, 0xffff0000, v8
    v_mul_f32 v11, v9, v9
    v_mul_f32 v11, 0x3d372713, v11
    v_fma_f32 v11, v11, v9, v9
    v_mul_f32 v11, s20, v11
    v_exp_f32 v11, v11
    s_nop 0
    v_add_f32 v11, 1.0, v11
    v_rcp_f32 v11, v11
    s_nop 0
    v_mul_f32 v11, v9, v11
    v_cvt_pk_bf16_f32 v11, v11, v11
    v_lshlrev_b32 v11, 16, v11
    v_mul_f32 v11, v11, v10
    v_cvt_pk_bf16_f32 v11, v11, v11
    ds_write_b16 v7, v11 offset:2000
    v_cvt_pk_bf16_f32 v8, v102, v150
    v_lshlrev_b32 v9, 16, v8
    v_and_b32 v10, 0xffff0000, v8
    v_mul_f32 v11, v9, v9
    v_mul_f32 v11, 0x3d372713, v11
    v_fma_f32 v11, v11, v9, v9
    v_mul_f32 v11, s20, v11
    v_exp_f32 v11, v11
    s_nop 0
    v_add_f32 v11, 1.0, v11
    v_rcp_f32 v11, v11
    s_nop 0
    v_mul_f32 v11, v9, v11
    v_cvt_pk_bf16_f32 v11, v11, v11
    v_lshlrev_b32 v11, 16, v11
    v_mul_f32 v11, v11, v10
    v_cvt_pk_bf16_f32 v11, v11, v11
    ds_write_b16 v7, v11 offset:2208
    v_cvt_pk_bf16_f32 v8, v103, v151
    v_lshlrev_b32 v9, 16, v8
    v_and_b32 v10, 0xffff0000, v8
    v_mul_f32 v11, v9, v9
    v_mul_f32 v11, 0x3d372713, v11
    v_fma_f32 v11, v11, v9, v9
    v_mul_f32 v11, s20, v11
    v_exp_f32 v11, v11
    s_nop 0
    v_add_f32 v11, 1.0, v11
    v_rcp_f32 v11, v11
    s_nop 0
    v_mul_f32 v11, v9, v11
    v_cvt_pk_bf16_f32 v11, v11, v11
    v_lshlrev_b32 v11, 16, v11
    v_mul_f32 v11, v11, v10
    v_cvt_pk_bf16_f32 v11, v11, v11
    ds_write_b16 v7, v11 offset:2416
    v_cvt_pk_bf16_f32 v8, v104, v152
    v_lshlrev_b32 v9, 16, v8
    v_and_b32 v10, 0xffff0000, v8
    v_mul_f32 v11, v9, v9
    v_mul_f32 v11, 0x3d372713, v11
    v_fma_f32 v11, v11, v9, v9
    v_mul_f32 v11, s20, v11
    v_exp_f32 v11, v11
    s_nop 0
    v_add_f32 v11, 1.0, v11
    v_rcp_f32 v11, v11
    s_nop 0
    v_mul_f32 v11, v9, v11
    v_cvt_pk_bf16_f32 v11, v11, v11
    v_lshlrev_b32 v11, 16, v11
    v_mul_f32 v11, v11, v10
    v_cvt_pk_bf16_f32 v11, v11, v11
    ds_write_b16 v7, v11 offset:3456
    v_cvt_pk_bf16_f32 v8, v105, v153
    v_lshlrev_b32 v9, 16, v8
    v_and_b32 v10, 0xffff0000, v8
    v_mul_f32 v11, v9, v9
    v_mul_f32 v11, 0x3d372713, v11
    v_fma_f32 v11, v11, v9, v9
    v_mul_f32 v11, s20, v11
    v_exp_f32 v11, v11
    s_nop 0
    v_add_f32 v11, 1.0, v11
    v_rcp_f32 v11, v11
    s_nop 0
    v_mul_f32 v11, v9, v11
    v_cvt_pk_bf16_f32 v11, v11, v11
    v_lshlrev_b32 v11, 16, v11
    v_mul_f32 v11, v11, v10
    v_cvt_pk_bf16_f32 v11, v11, v11
    ds_write_b16 v7, v11 offset:3664
    v_cvt_pk_bf16_f32 v8, v106, v154
    v_lshlrev_b32 v9, 16, v8
    v_and_b32 v10, 0xffff0000, v8
    v_mul_f32 v11, v9, v9
    v_mul_f32 v11, 0x3d372713, v11
    v_fma_f32 v11, v11, v9, v9
    v_mul_f32 v11, s20, v11
    v_exp_f32 v11, v11
    s_nop 0
    v_add_f32 v11, 1.0, v11
    v_rcp_f32 v11, v11
    s_nop 0
    v_mul_f32 v11, v9, v11
    v_cvt_pk_bf16_f32 v11, v11, v11
    v_lshlrev_b32 v11, 16, v11
    v_mul_f32 v11, v11, v10
    v_cvt_pk_bf16_f32 v11, v11, v11
    ds_write_b16 v7, v11 offset:3872
    v_cvt_pk_bf16_f32 v8, v107, v155
    v_lshlrev_b32 v9, 16, v8
    v_and_b32 v10, 0xffff0000, v8
    v_mul_f32 v11, v9, v9
    v_mul_f32 v11, 0x3d372713, v11
    v_fma_f32 v11, v11, v9, v9
    v_mul_f32 v11, s20, v11
    v_exp_f32 v11, v11
    s_nop 0
    v_add_f32 v11, 1.0, v11
    v_rcp_f32 v11, v11
    s_nop 0
    v_mul_f32 v11, v9, v11
    v_cvt_pk_bf16_f32 v11, v11, v11
    v_lshlrev_b32 v11, 16, v11
    v_mul_f32 v11, v11, v10
    v_cvt_pk_bf16_f32 v11, v11, v11
    ds_write_b16 v7, v11 offset:4080
    v_cvt_pk_bf16_f32 v8, v108, v156
    v_lshlrev_b32 v9, 16, v8
    v_and_b32 v10, 0xffff0000, v8
    v_mul_f32 v11, v9, v9
    v_mul_f32 v11, 0x3d372713, v11
    v_fma_f32 v11, v11, v9, v9
    v_mul_f32 v11, s20, v11
    v_exp_f32 v11, v11
    s_nop 0
    v_add_f32 v11, 1.0, v11
    v_rcp_f32 v11, v11
    s_nop 0
    v_mul_f32 v11, v9, v11
    v_cvt_pk_bf16_f32 v11, v11, v11
    v_lshlrev_b32 v11, 16, v11
    v_mul_f32 v11, v11, v10
    v_cvt_pk_bf16_f32 v11, v11, v11
    ds_write_b16 v7, v11 offset:5120
    v_cvt_pk_bf16_f32 v8, v109, v157
    v_lshlrev_b32 v9, 16, v8
    v_and_b32 v10, 0xffff0000, v8
    v_mul_f32 v11, v9, v9
    v_mul_f32 v11, 0x3d372713, v11
    v_fma_f32 v11, v11, v9, v9
    v_mul_f32 v11, s20, v11
    v_exp_f32 v11, v11
    s_nop 0
    v_add_f32 v11, 1.0, v11
    v_rcp_f32 v11, v11
    s_nop 0
    v_mul_f32 v11, v9, v11
    v_cvt_pk_bf16_f32 v11, v11, v11
    v_lshlrev_b32 v11, 16, v11
    v_mul_f32 v11, v11, v10
    v_cvt_pk_bf16_f32 v11, v11, v11
    ds_write_b16 v7, v11 offset:5328
    v_cvt_pk_bf16_f32 v8, v110, v158
    v_lshlrev_b32 v9, 16, v8
    v_and_b32 v10, 0xffff0000, v8
    v_mul_f32 v11, v9, v9
    v_mul_f32 v11, 0x3d372713, v11
    v_fma_f32 v11, v11, v9, v9
    v_mul_f32 v11, s20, v11
    v_exp_f32 v11, v11
    s_nop 0
    v_add_f32 v11, 1.0, v11
    v_rcp_f32 v11, v11
    s_nop 0
    v_mul_f32 v11, v9, v11
    v_cvt_pk_bf16_f32 v11, v11, v11
    v_lshlrev_b32 v11, 16, v11
    v_mul_f32 v11, v11, v10
    v_cvt_pk_bf16_f32 v11, v11, v11
    ds_write_b16 v7, v11 offset:5536
    v_cvt_pk_bf16_f32 v8, v111, v159
    v_lshlrev_b32 v9, 16, v8
    v_and_b32 v10, 0xffff0000, v8
    v_mul_f32 v11, v9, v9
    v_mul_f32 v11, 0x3d372713, v11
    v_fma_f32 v11, v11, v9, v9
    v_mul_f32 v11, s20, v11
    v_exp_f32 v11, v11
    s_nop 0
    v_add_f32 v11, 1.0, v11
    v_rcp_f32 v11, v11
    s_nop 0
    v_mul_f32 v11, v9, v11
    v_cvt_pk_bf16_f32 v11, v11, v11
    v_lshlrev_b32 v11, 16, v11
    v_mul_f32 v11, v11, v10
    v_cvt_pk_bf16_f32 v11, v11, v11
    ds_write_b16 v7, v11 offset:5744
    s_waitcnt lgkmcnt(0)
    s_lshl_b32 s8, s4, 2
    s_add_u32 s8, s8, s6
    s_mul_i32 s8, s8, 90112
    s_mul_i32 s9, s5, 6144
    s_add_u32 s8, s8, s9
    s_add_u32 s8, s8, 10616832
    v_add_u32 v8, 0, v1
    v_mul_u32_u24 v9, 5462, v8
    v_lshrrev_b32 v9, 16, v9
    v_mul_u32_u24 v10, 12, v9
    v_sub_u32 v10, v8, v10
    v_mul_u32_u24 v11, 208, v9
    v_lshl_add_u32 v11, v10, 4, v11
    v_add_u32 v11, s13, v11
    ds_read_b128 v[12:15], v11
    v_lshrrev_b32 v16, 1, v10
    v_and_b32 v17, 1, v10
    v_lshlrev_b32 v18, 10, v16
    v_lshl_add_u32 v18, v17, 9, v18
    v_lshl_add_u32 v18, v9, 4, v18
    s_mul_i32 s15, s5, 6
    v_add_u32 v16, s15, v16
    v_cmp_gt_u32 vcc, 86, v16
    s_waitcnt lgkmcnt(0)
    s_and_saveexec_b64 s[30:31], vcc
    buffer_store_dwordx4 v[12:15], v18, s[24:27], s8 offen
    s_mov_b64 exec, s[30:31]
    s_waitcnt vmcnt(0)
    v_add_u32 v8, 64, v1
    v_mul_u32_u24 v9, 5462, v8
    v_lshrrev_b32 v9, 16, v9
    v_mul_u32_u24 v10, 12, v9
    v_sub_u32 v10, v8, v10
    v_mul_u32_u24 v11, 208, v9
    v_lshl_add_u32 v11, v10, 4, v11
    v_add_u32 v11, s13, v11
    ds_read_b128 v[12:15], v11
    v_lshrrev_b32 v16, 1, v10
    v_and_b32 v17, 1, v10
    v_lshlrev_b32 v18, 10, v16
    v_lshl_add_u32 v18, v17, 9, v18
    v_lshl_add_u32 v18, v9, 4, v18
    s_mul_i32 s15, s5, 6
    v_add_u32 v16, s15, v16
    v_cmp_gt_u32 vcc, 86, v16
    s_waitcnt lgkmcnt(0)
    s_and_saveexec_b64 s[30:31], vcc
    buffer_store_dwordx4 v[12:15], v18, s[24:27], s8 offen
    s_mov_b64 exec, s[30:31]
    s_waitcnt vmcnt(0)
    v_add_u32 v8, 128, v1
    v_mul_u32_u24 v9, 5462, v8
    v_lshrrev_b32 v9, 16, v9
    v_mul_u32_u24 v10, 12, v9
    v_sub_u32 v10, v8, v10
    v_mul_u32_u24 v11, 208, v9
    v_lshl_add_u32 v11, v10, 4, v11
    v_add_u32 v11, s13, v11
    ds_read_b128 v[12:15], v11
    v_lshrrev_b32 v16, 1, v10
    v_and_b32 v17, 1, v10
    v_lshlrev_b32 v18, 10, v16
    v_lshl_add_u32 v18, v17, 9, v18
    v_lshl_add_u32 v18, v9, 4, v18
    s_mul_i32 s15, s5, 6
    v_add_u32 v16, s15, v16
    v_cmp_gt_u32 vcc, 86, v16
    s_waitcnt lgkmcnt(0)
    s_and_saveexec_b64 s[30:31], vcc
    buffer_store_dwordx4 v[12:15], v18, s[24:27], s8 offen
    s_mov_b64 exec, s[30:31]
    s_waitcnt vmcnt(0)
    v_add_u32 v8, 192, v1
    v_mul_u32_u24 v9, 5462, v8
    v_lshrrev_b32 v9, 16, v9
    v_mul_u32_u24 v10, 12, v9
    v_sub_u32 v10, v8, v10
    v_mul_u32_u24 v11, 208, v9
    v_lshl_add_u32 v11, v10, 4, v11
    v_add_u32 v11, s13, v11
    ds_read_b128 v[12:15], v11
    v_lshrrev_b32 v16, 1, v10
    v_and_b32 v17, 1, v10
    v_lshlrev_b32 v18, 10, v16
    v_lshl_add_u32 v18, v17, 9, v18
    v_lshl_add_u32 v18, v9, 4, v18
    s_mul_i32 s15, s5, 6
    v_add_u32 v16, s15, v16
    v_cmp_gt_u32 vcc, 86, v16
    s_waitcnt lgkmcnt(0)
    s_and_saveexec_b64 s[30:31], vcc
    buffer_store_dwordx4 v[12:15], v18, s[24:27], s8 offen
    s_mov_b64 exec, s[30:31]
    s_waitcnt vmcnt(0)
    v_add_u32 v8, 256, v1
    v_mul_u32_u24 v9, 5462, v8
    v_lshrrev_b32 v9, 16, v9
    v_mul_u32_u24 v10, 12, v9
    v_sub_u32 v10, v8, v10
    v_mul_u32_u24 v11, 208, v9
    v_lshl_add_u32 v11, v10, 4, v11
    v_add_u32 v11, s13, v11
    ds_read_b128 v[12:15], v11
    v_lshrrev_b32 v16, 1, v10
    v_and_b32 v17, 1, v10
    v_lshlrev_b32 v18, 10, v16
    v_lshl_add_u32 v18, v17, 9, v18
    v_lshl_add_u32 v18, v9, 4, v18
    s_mul_i32 s15, s5, 6
    v_add_u32 v16, s15, v16
    v_cmp_gt_u32 vcc, 86, v16
    s_waitcnt lgkmcnt(0)
    s_and_saveexec_b64 s[30:31], vcc
    buffer_store_dwordx4 v[12:15], v18, s[24:27], s8 offen
    s_mov_b64 exec, s[30:31]
    s_waitcnt vmcnt(0)
    v_add_u32 v8, 320, v1
    v_mul_u32_u24 v9, 5462, v8
    v_lshrrev_b32 v9, 16, v9
    v_mul_u32_u24 v10, 12, v9
    v_sub_u32 v10, v8, v10
    v_mul_u32_u24 v11, 208, v9
    v_lshl_add_u32 v11, v10, 4, v11
    v_add_u32 v11, s13, v11
    ds_read_b128 v[12:15], v11
    v_lshrrev_b32 v16, 1, v10
    v_and_b32 v17, 1, v10
    v_lshlrev_b32 v18, 10, v16
    v_lshl_add_u32 v18, v17, 9, v18
    v_lshl_add_u32 v18, v9, 4, v18
    s_mul_i32 s15, s5, 6
    v_add_u32 v16, s15, v16
    v_cmp_gt_u32 vcc, 86, v16
    s_waitcnt lgkmcnt(0)
    s_and_saveexec_b64 s[30:31], vcc
    buffer_store_dwordx4 v[12:15], v18, s[24:27], s8 offen
    s_mov_b64 exec, s[30:31]
    s_waitcnt vmcnt(0)
k4_kernel_end:
    s_endpgm
.globl k5_kernel
.p2align 8
.type k5_kernel,@function
k5_kernel:
    s_load_dwordx2 s[10:11], s[0:1], 72
    s_load_dwordx2 s[12:13], s[0:1], 56
    s_cmp_ge_u32 s2, 256
    s_cbranch_scc1 k5_kernel_end
    s_waitcnt lgkmcnt(0)
    s_mov_b32 s24, s10
    s_and_b32 s25, s11, 0xffff
    s_mov_b32 s26, 20971520
    s_mov_b32 s27, 0x00020000
    s_mov_b32 s28, s12
    s_and_b32 s29, s13, 0xffff
    s_mov_b32 s30, 2097152
    s_mov_b32 s31, 0x00020000
    s_lshr_b32 s4, s2, 3
    s_and_b32 s5, s2, 7
    v_and_b32 v1, 63, v0
    v_lshrrev_b32 v2, 6, v0
    s_nop 1
    v_readfirstlane_b32 s6, v2
    v_lshlrev_b32 v3, 4, v1
    s_lshl_b32 s8, s4, 1
    s_add_u32 s8, s8, s6
    s_mov_b32 s16, s8
    s_mul_i32 s8, s8, 90112
    s_add_u32 s8, s8, 10616832
    s_mul_i32 s9, s5, 176128
    s_add_u32 s9, s9, 19333120
    v_mov_b32 v64, 0
    v_mov_b32 v65, 0
    v_mov_b32 v66, 0
    v_mov_b32 v67, 0
    v_mov_b32 v68, 0
    v_mov_b32 v69, 0
    v_mov_b32 v70, 0
    v_mov_b32 v71, 0
    v_mov_b32 v72, 0
    v_mov_b32 v73, 0
    v_mov_b32 v74, 0
    v_mov_b32 v75, 0
    v_mov_b32 v76, 0
    v_mov_b32 v77, 0
    v_mov_b32 v78, 0
    v_mov_b32 v79, 0
    v_mov_b32 v80, 0
    v_mov_b32 v81, 0
    v_mov_b32 v82, 0
    v_mov_b32 v83, 0
    v_mov_b32 v84, 0
    v_mov_b32 v85, 0
    v_mov_b32 v86, 0
    v_mov_b32 v87, 0
    v_mov_b32 v88, 0
    v_mov_b32 v89, 0
    v_mov_b32 v90, 0
    v_mov_b32 v91, 0
    v_mov_b32 v92, 0
    v_mov_b32 v93, 0
    v_mov_b32 v94, 0
    v_mov_b32 v95, 0
    buffer_load_dwordx4 v[8:11], v3, s[24:27], s8 offen offset:0
    buffer_load_dwordx4 v[12:15], v3, s[24:27], s9 offen offset:0
    s_add_u32 s14, s9, 88064
    buffer_load_dwordx4 v[16:19], v3, s[24:27], s14 offen offset:0
    s_add_u32 s8, s8, 1024
    s_add_u32 s9, s9, 1024
    buffer_load_dwordx4 v[20:23], v3, s[24:27], s8 offen offset:0
    buffer_load_dwordx4 v[24:27], v3, s[24:27], s9 offen offset:0
    s_add_u32 s14, s9, 88064
    buffer_load_dwordx4 v[28:31], v3, s[24:27], s14 offen offset:0
    s_add_u32 s8, s8, 1024
    s_add_u32 s9, s9, 1024
    buffer_load_dwordx4 v[32:35], v3, s[24:27], s8 offen offset:0
    buffer_load_dwordx4 v[36:39], v3, s[24:27], s9 offen offset:0
    s_add_u32 s14, s9, 88064
    buffer_load_dwordx4 v[40:43], v3, s[24:27], s14 offen offset:0
    s_add_u32 s8, s8, 1024
    s_add_u32 s9, s9, 1024
    buffer_load_dwordx4 v[44:47], v3, s[24:27], s8 offen offset:0
    buffer_load_dwordx4 v[48:51], v3, s[24:27], s9 offen offset:0
    s_add_u32 s14, s9, 88064
    buffer_load_dwordx4 v[52:55], v3, s[24:27], s14 offen offset:0
    s_add_u32 s8, s8, 1024
    s_add_u32 s9, s9, 1024
    s_waitcnt vmcnt(9)
    v_mfma_f32_32x32x16_bf16 v[64:79], v[8:11], v[12:15], v[64:79]
    v_mfma_f32_32x32x16_bf16 v[80:95], v[8:11], v[16:19], v[80:95]
    buffer_load_dwordx4 v[8:11], v3, s[24:27], s8 offen offset:0
    buffer_load_dwordx4 v[12:15], v3, s[24:27], s9 offen offset:0
    s_add_u32 s14, s9, 88064
    buffer_load_dwordx4 v[16:19], v3, s[24:27], s14 offen offset:0
    s_add_u32 s8, s8, 1024
    s_add_u32 s9, s9, 1024
    s_waitcnt vmcnt(9)
    v_mfma_f32_32x32x16_bf16 v[64:79], v[20:23], v[24:27], v[64:79]
    v_mfma_f32_32x32x16_bf16 v[80:95], v[20:23], v[28:31], v[80:95]
    buffer_load_dwordx4 v[20:23], v3, s[24:27], s8 offen offset:0
    buffer_load_dwordx4 v[24:27], v3, s[24:27], s9 offen offset:0
    s_add_u32 s14, s9, 88064
    buffer_load_dwordx4 v[28:31], v3, s[24:27], s14 offen offset:0
    s_add_u32 s8, s8, 1024
    s_add_u32 s9, s9, 1024
    s_waitcnt vmcnt(9)
    v_mfma_f32_32x32x16_bf16 v[64:79], v[32:35], v[36:39], v[64:79]
    v_mfma_f32_32x32x16_bf16 v[80:95], v[32:35], v[40:43], v[80:95]
    buffer_load_dwordx4 v[32:35], v3, s[24:27], s8 offen offset:0
    buffer_load_dwordx4 v[36:39], v3, s[24:27], s9 offen offset:0
    s_add_u32 s14, s9, 88064
    buffer_load_dwordx4 v[40:43], v3, s[24:27], s14 offen offset:0
    s_add_u32 s8, s8, 1024
    s_add_u32 s9, s9, 1024
    s_waitcnt vmcnt(9)
    v_mfma_f32_32x32x16_bf16 v[64:79], v[44:47], v[48:51], v[64:79]
    v_mfma_f32_32x32x16_bf16 v[80:95], v[44:47], v[52:55], v[80:95]
    buffer_load_dwordx4 v[44:47], v3, s[24:27], s8 offen offset:0
    buffer_load_dwordx4 v[48:51], v3, s[24:27], s9 offen offset:0
    s_add_u32 s14, s9, 88064
    buffer_load_dwordx4 v[52:55], v3, s[24:27], s14 offen offset:0
    s_add_u32 s8, s8, 1024
    s_add_u32 s9, s9, 1024
    s_waitcnt vmcnt(9)
    v_mfma_f32_32x32x16_bf16 v[64:79], v[8:11], v[12:15], v[64:79]
    v_mfma_f32_32x32x16_bf16 v[80:95], v[8:11], v[16:19], v[80:95]
    buffer_load_dwordx4 v[8:11], v3, s[24:27], s8 offen offset:0
    buffer_load_dwordx4 v[12:15], v3, s[24:27], s9 offen offset:0
    s_add_u32 s14, s9, 88064
    buffer_load_dwordx4 v[16:19], v3, s[24:27], s14 offen offset:0
    s_add_u32 s8, s8, 1024
    s_add_u32 s9, s9, 1024
    s_waitcnt vmcnt(9)
    v_mfma_f32_32x32x16_bf16 v[64:79], v[20:23], v[24:27], v[64:79]
    v_mfma_f32_32x32x16_bf16 v[80:95], v[20:23], v[28:31], v[80:95]
    buffer_load_dwordx4 v[20:23], v3, s[24:27], s8 offen offset:0
    buffer_load_dwordx4 v[24:27], v3, s[24:27], s9 offen offset:0
    s_add_u32 s14, s9, 88064
    buffer_load_dwordx4 v[28:31], v3, s[24:27], s14 offen offset:0
    s_add_u32 s8, s8, 1024
    s_add_u32 s9, s9, 1024
    s_waitcnt vmcnt(9)
    v_mfma_f32_32x32x16_bf16 v[64:79], v[32:35], v[36:39], v[64:79]
    v_mfma_f32_32x32x16_bf16 v[80:95], v[32:35], v[40:43], v[80:95]
    buffer_load_dwordx4 v[32:35], v3, s[24:27], s8 offen offset:0
    buffer_load_dwordx4 v[36:39], v3, s[24:27], s9 offen offset:0
    s_add_u32 s14, s9, 88064
    buffer_load_dwordx4 v[40:43], v3, s[24:27], s14 offen offset:0
    s_add_u32 s8, s8, 1024
    s_add_u32 s9, s9, 1024
    s_waitcnt vmcnt(9)
    v_mfma_f32_32x32x16_bf16 v[64:79], v[44:47], v[48:51], v[64:79]
    v_mfma_f32_32x32x16_bf16 v[80:95], v[44:47], v[52:55], v[80:95]
    buffer_load_dwordx4 v[44:47], v3, s[24:27], s8 offen offset:0
    buffer_load_dwordx4 v[48:51], v3, s[24:27], s9 offen offset:0
    s_add_u32 s14, s9, 88064
    buffer_load_dwordx4 v[52:55], v3, s[24:27], s14 offen offset:0
    s_add_u32 s8, s8, 1024
    s_add_u32 s9, s9, 1024
    s_waitcnt vmcnt(9)
    v_mfma_f32_32x32x16_bf16 v[64:79], v[8:11], v[12:15], v[64:79]
    v_mfma_f32_32x32x16_bf16 v[80:95], v[8:11], v[16:19], v[80:95]
    buffer_load_dwordx4 v[8:11], v3, s[24:27], s8 offen offset:0
    buffer_load_dwordx4 v[12:15], v3, s[24:27], s9 offen offset:0
    s_add_u32 s14, s9, 88064
    buffer_load_dwordx4 v[16:19], v3, s[24:27], s14 offen offset:0
    s_add_u32 s8, s8, 1024
    s_add_u32 s9, s9, 1024
    s_waitcnt vmcnt(9)
    v_mfma_f32_32x32x16_bf16 v[64:79], v[20:23], v[24:27], v[64:79]
    v_mfma_f32_32x32x16_bf16 v[80:95], v[20:23], v[28:31], v[80:95]
    buffer_load_dwordx4 v[20:23], v3, s[24:27], s8 offen offset:0
    buffer_load_dwordx4 v[24:27], v3, s[24:27], s9 offen offset:0
    s_add_u32 s14, s9, 88064
    buffer_load_dwordx4 v[28:31], v3, s[24:27], s14 offen offset:0
    s_add_u32 s8, s8, 1024
    s_add_u32 s9, s9, 1024
    s_waitcnt vmcnt(9)
    v_mfma_f32_32x32x16_bf16 v[64:79], v[32:35], v[36:39], v[64:79]
    v_mfma_f32_32x32x16_bf16 v[80:95], v[32:35], v[40:43], v[80:95]
    buffer_load_dwordx4 v[32:35], v3, s[24:27], s8 offen offset:0
    buffer_load_dwordx4 v[36:39], v3, s[24:27], s9 offen offset:0
    s_add_u32 s14, s9, 88064
    buffer_load_dwordx4 v[40:43], v3, s[24:27], s14 offen offset:0
    s_add_u32 s8, s8, 1024
    s_add_u32 s9, s9, 1024
    s_waitcnt vmcnt(9)
    v_mfma_f32_32x32x16_bf16 v[64:79], v[44:47], v[48:51], v[64:79]
    v_mfma_f32_32x32x16_bf16 v[80:95], v[44:47], v[52:55], v[80:95]
    buffer_load_dwordx4 v[44:47], v3, s[24:27], s8 offen offset:0
    buffer_load_dwordx4 v[48:51], v3, s[24:27], s9 offen offset:0
    s_add_u32 s14, s9, 88064
    buffer_load_dwordx4 v[52:55], v3, s[24:27], s14 offen offset:0
    s_add_u32 s8, s8, 1024
    s_add_u32 s9, s9, 1024
    s_waitcnt vmcnt(9)
    v_mfma_f32_32x32x16_bf16 v[64:79], v[8:11], v[12:15], v[64:79]
    v_mfma_f32_32x32x16_bf16 v[80:95], v[8:11], v[16:19], v[80:95]
    buffer_load_dwordx4 v[8:11], v3, s[24:27], s8 offen offset:0
    buffer_load_dwordx4 v[12:15], v3, s[24:27], s9 offen offset:0
    s_add_u32 s14, s9, 88064
    buffer_load_dwordx4 v[16:19], v3, s[24:27], s14 offen offset:0
    s_add_u32 s8, s8, 1024
    s_add_u32 s9, s9, 1024
    s_waitcnt vmcnt(9)
    v_mfma_f32_32x32x16_bf16 v[64:79], v[20:23], v[24:27], v[64:79]
    v_mfma_f32_32x32x16_bf16 v[80:95], v[20:23], v[28:31], v[80:95]
    buffer_load_dwordx4 v[20:23], v3, s[24:27], s8 offen offset:0
    buffer_load_dwordx4 v[24:27], v3, s[24:27], s9 offen offset:0
    s_add_u32 s14, s9, 88064
    buffer_load_dwordx4 v[28:31], v3, s[24:27], s14 offen offset:0
    s_add_u32 s8, s8, 1024
    s_add_u32 s9, s9, 1024
    s_waitcnt vmcnt(9)
    v_mfma_f32_32x32x16_bf16 v[64:79], v[32:35], v[36:39], v[64:79]
    v_mfma_f32_32x32x16_bf16 v[80:95], v[32:35], v[40:43], v[80:95]
    buffer_load_dwordx4 v[32:35], v3, s[24:27], s8 offen offset:0
    buffer_load_dwordx4 v[36:39], v3, s[24:27], s9 offen offset:0
    s_add_u32 s14, s9, 88064
    buffer_load_dwordx4 v[40:43], v3, s[24:27], s14 offen offset:0
    s_add_u32 s8, s8, 1024
    s_add_u32 s9, s9, 1024
    s_waitcnt vmcnt(9)
    v_mfma_f32_32x32x16_bf16 v[64:79], v[44:47], v[48:51], v[64:79]
    v_mfma_f32_32x32x16_bf16 v[80:95], v[44:47], v[52:55], v[80:95]
    buffer_load_dwordx4 v[44:47], v3, s[24:27], s8 offen offset:0
    buffer_load_dwordx4 v[48:51], v3, s[24:27], s9 offen offset:0
    s_add_u32 s14, s9, 88064
    buffer_load_dwordx4 v[52:55], v3, s[24:27], s14 offen offset:0
    s_add_u32 s8, s8, 1024
    s_add_u32 s9, s9, 1024
    s_waitcnt vmcnt(9)
    v_mfma_f32_32x32x16_bf16 v[64:79], v[8:11], v[12:15], v[64:79]
    v_mfma_f32_32x32x16_bf16 v[80:95], v[8:11], v[16:19], v[80:95]
    buffer_load_dwordx4 v[8:11], v3, s[24:27], s8 offen offset:0
    buffer_load_dwordx4 v[12:15], v3, s[24:27], s9 offen offset:0
    s_add_u32 s14, s9, 88064
    buffer_load_dwordx4 v[16:19], v3, s[24:27], s14 offen offset:0
    s_add_u32 s8, s8, 1024
    s_add_u32 s9, s9, 1024
    s_waitcnt vmcnt(9)
    v_mfma_f32_32x32x16_bf16 v[64:79], v[20:23], v[24:27], v[64:79]
    v_mfma_f32_32x32x16_bf16 v[80:95], v[20:23], v[28:31], v[80:95]
    buffer_load_dwordx4 v[20:23], v3, s[24:27], s8 offen offset:0
    buffer_load_dwordx4 v[24:27], v3, s[24:27], s9 offen offset:0
    s_add_u32 s14, s9, 88064
    buffer_load_dwordx4 v[28:31], v3, s[24:27], s14 offen offset:0
    s_add_u32 s8, s8, 1024
    s_add_u32 s9, s9, 1024
    s_waitcnt vmcnt(9)
    v_mfma_f32_32x32x16_bf16 v[64:79], v[32:35], v[36:39], v[64:79]
    v_mfma_f32_32x32x16_bf16 v[80:95], v[32:35], v[40:43], v[80:95]
    buffer_load_dwordx4 v[32:35], v3, s[24:27], s8 offen offset:0
    buffer_load_dwordx4 v[36:39], v3, s[24:27], s9 offen offset:0
    s_add_u32 s14, s9, 88064
    buffer_load_dwordx4 v[40:43], v3, s[24:27], s14 offen offset:0
    s_add_u32 s8, s8, 1024
    s_add_u32 s9, s9, 1024
    s_waitcnt vmcnt(9)
    v_mfma_f32_32x32x16_bf16 v[64:79], v[44:47], v[48:51], v[64:79]
    v_mfma_f32_32x32x16_bf16 v[80:95], v[44:47], v[52:55], v[80:95]
    buffer_load_dwordx4 v[44:47], v3, s[24:27], s8 offen offset:0
    buffer_load_dwordx4 v[48:51], v3, s[24:27], s9 offen offset:0
    s_add_u32 s14, s9, 88064
    buffer_load_dwordx4 v[52:55], v3, s[24:27], s14 offen offset:0
    s_add_u32 s8, s8, 1024
    s_add_u32 s9, s9, 1024
    s_waitcnt vmcnt(9)
    v_mfma_f32_32x32x16_bf16 v[64:79], v[8:11], v[12:15], v[64:79]
    v_mfma_f32_32x32x16_bf16 v[80:95], v[8:11], v[16:19], v[80:95]
    buffer_load_dwordx4 v[8:11], v3, s[24:27], s8 offen offset:0
    buffer_load_dwordx4 v[12:15], v3, s[24:27], s9 offen offset:0
    s_add_u32 s14, s9, 88064
    buffer_load_dwordx4 v[16:19], v3, s[24:27], s14 offen offset:0
    s_add_u32 s8, s8, 1024
    s_add_u32 s9, s9, 1024
    s_waitcnt vmcnt(9)
    v_mfma_f32_32x32x16_bf16 v[64:79], v[20:23], v[24:27], v[64:79]
    v_mfma_f32_32x32x16_bf16 v[80:95], v[20:23], v[28:31], v[80:95]
    buffer_load_dwordx4 v[20:23], v3, s[24:27], s8 offen offset:0
    buffer_load_dwordx4 v[24:27], v3, s[24:27], s9 offen offset:0
    s_add_u32 s14, s9, 88064
    buffer_load_dwordx4 v[28:31], v3, s[24:27], s14 offen offset:0
    s_add_u32 s8, s8, 1024
    s_add_u32 s9, s9, 1024
    s_waitcnt vmcnt(9)
    v_mfma_f32_32x32x16_bf16 v[64:79], v[32:35], v[36:39], v[64:79]
    v_mfma_f32_32x32x16_bf16 v[80:95], v[32:35], v[40:43], v[80:95]
    buffer_load_dwordx4 v[32:35], v3, s[24:27], s8 offen offset:0
    buffer_load_dwordx4 v[36:39], v3, s[24:27], s9 offen offset:0
    s_add_u32 s14, s9, 88064
    buffer_load_dwordx4 v[40:43], v3, s[24:27], s14 offen offset:0
    s_add_u32 s8, s8, 1024
    s_add_u32 s9, s9, 1024
    s_waitcnt vmcnt(9)
    v_mfma_f32_32x32x16_bf16 v[64:79], v[44:47], v[48:51], v[64:79]
    v_mfma_f32_32x32x16_bf16 v[80:95], v[44:47], v[52:55], v[80:95]
    buffer_load_dwordx4 v[44:47], v3, s[24:27], s8 offen offset:0
    buffer_load_dwordx4 v[48:51], v3, s[24:27], s9 offen offset:0
    s_add_u32 s14, s9, 88064
    buffer_load_dwordx4 v[52:55], v3, s[24:27], s14 offen offset:0
    s_add_u32 s8, s8, 1024
    s_add_u32 s9, s9, 1024
    s_waitcnt vmcnt(9)
    v_mfma_f32_32x32x16_bf16 v[64:79], v[8:11], v[12:15], v[64:79]
    v_mfma_f32_32x32x16_bf16 v[80:95], v[8:11], v[16:19], v[80:95]
    buffer_load_dwordx4 v[8:11], v3, s[24:27], s8 offen offset:0
    buffer_load_dwordx4 v[12:15], v3, s[24:27], s9 offen offset:0
    s_add_u32 s14, s9, 88064
    buffer_load_dwordx4 v[16:19], v3, s[24:27], s14 offen offset:0
    s_add_u32 s8, s8, 1024
    s_add_u32 s9, s9, 1024
    s_waitcnt vmcnt(9)
    v_mfma_f32_32x32x16_bf16 v[64:79], v[20:23], v[24:27], v[64:79]
    v_mfma_f32_32x32x16_bf16 v[80:95], v[20:23], v[28:31], v[80:95]
    buffer_load_dwordx4 v[20:23], v3, s[24:27], s8 offen offset:0
    buffer_load_dwordx4 v[24:27], v3, s[24:27], s9 offen offset:0
    s_add_u32 s14, s9, 88064
    buffer_load_dwordx4 v[28:31], v3, s[24:27], s14 offen offset:0
    s_add_u32 s8, s8, 1024
    s_add_u32 s9, s9, 1024
    s_waitcnt vmcnt(9)
    v_mfma_f32_32x32x16_bf16 v[64:79], v[32:35], v[36:39], v[64:79]
    v_mfma_f32_32x32x16_bf16 v[80:95], v[32:35], v[40:43], v[80:95]
    buffer_load_dwordx4 v[32:35], v3, s[24:27], s8 offen offset:0
    buffer_load_dwordx4 v[36:39], v3, s[24:27], s9 offen offset:0
    s_add_u32 s14, s9, 88064
    buffer_load_dwordx4 v[40:43], v3, s[24:27], s14 offen offset:0
    s_add_u32 s8, s8, 1024
    s_add_u32 s9, s9, 1024
    s_waitcnt vmcnt(9)
    v_mfma_f32_32x32x16_bf16 v[64:79], v[44:47], v[48:51], v[64:79]
    v_mfma_f32_32x32x16_bf16 v[80:95], v[44:47], v[52:55], v[80:95]
    buffer_load_dwordx4 v[44:47], v3, s[24:27], s8 offen offset:0
    buffer_load_dwordx4 v[48:51], v3, s[24:27], s9 offen offset:0
    s_add_u32 s14, s9, 88064
    buffer_load_dwordx4 v[52:55], v3, s[24:27], s14 offen offset:0
    s_add_u32 s8, s8, 1024
    s_add_u32 s9, s9, 1024
    s_waitcnt vmcnt(9)
    v_mfma_f32_32x32x16_bf16 v[64:79], v[8:11], v[12:15], v[64:79]
    v_mfma_f32_32x32x16_bf16 v[80:95], v[8:11], v[16:19], v[80:95]
    buffer_load_dwordx4 v[8:11], v3, s[24:27], s8 offen offset:0
    buffer_load_dwordx4 v[12:15], v3, s[24:27], s9 offen offset:0
    s_add_u32 s14, s9, 88064
    buffer_load_dwordx4 v[16:19], v3, s[24:27], s14 offen offset:0
    s_add_u32 s8, s8, 1024
    s_add_u32 s9, s9, 1024
    s_waitcnt vmcnt(9)
    v_mfma_f32_32x32x16_bf16 v[64:79], v[20:23], v[24:27], v[64:79]
    v_mfma_f32_32x32x16_bf16 v[80:95], v[20:23], v[28:31], v[80:95]
    buffer_load_dwordx4 v[20:23], v3, s[24:27], s8 offen offset:0
    buffer_load_dwordx4 v[24:27], v3, s[24:27], s9 offen offset:0
    s_add_u32 s14, s9, 88064
    buffer_load_dwordx4 v[28:31], v3, s[24:27], s14 offen offset:0
    s_add_u32 s8, s8, 1024
    s_add_u32 s9, s9, 1024
    s_waitcnt vmcnt(9)
    v_mfma_f32_32x32x16_bf16 v[64:79], v[32:35], v[36:39], v[64:79]
    v_mfma_f32_32x32x16_bf16 v[80:95], v[32:35], v[40:43], v[80:95]
    buffer_load_dwordx4 v[32:35], v3, s[24:27], s8 offen offset:0
    buffer_load_dwordx4 v[36:39], v3, s[24:27], s9 offen offset:0
    s_add_u32 s14, s9, 88064
    buffer_load_dwordx4 v[40:43], v3, s[24:27], s14 offen offset:0
    s_add_u32 s8, s8, 1024
    s_add_u32 s9, s9, 1024
    s_waitcnt vmcnt(9)
    v_mfma_f32_32x32x16_bf16 v[64:79], v[44:47], v[48:51], v[64:79]
    v_mfma_f32_32x32x16_bf16 v[80:95], v[44:47], v[52:55], v[80:95]
    buffer_load_dwordx4 v[44:47], v3, s[24:27], s8 offen offset:0
    buffer_load_dwordx4 v[48:51], v3, s[24:27], s9 offen offset:0
    s_add_u32 s14, s9, 88064
    buffer_load_dwordx4 v[52:55], v3, s[24:27], s14 offen offset:0
    s_add_u32 s8, s8, 1024
    s_add_u32 s9, s9, 1024
    s_waitcnt vmcnt(9)
    v_mfma_f32_32x32x16_bf16 v[64:79], v[8:11], v[12:15], v[64:79]
    v_mfma_f32_32x32x16_bf16 v[80:95], v[8:11], v[16:19], v[80:95]
    buffer_load_dwordx4 v[8:11], v3, s[24:27], s8 offen offset:0
    buffer_load_dwordx4 v[12:15], v3, s[24:27], s9 offen offset:0
    s_add_u32 s14, s9, 88064
    buffer_load_dwordx4 v[16:19], v3, s[24:27], s14 offen offset:0
    s_add_u32 s8, s8, 1024
    s_add_u32 s9, s9, 1024
    s_waitcnt vmcnt(9)
    v_mfma_f32_32x32x16_bf16 v[64:79], v[20:23], v[24:27], v[64:79]
    v_mfma_f32_32x32x16_bf16 v[80:95], v[20:23], v[28:31], v[80:95]
    buffer_load_dwordx4 v[20:23], v3, s[24:27], s8 offen offset:0
    buffer_load_dwordx4 v[24:27], v3, s[24:27], s9 offen offset:0
    s_add_u32 s14, s9, 88064
    buffer_load_dwordx4 v[28:31], v3, s[24:27], s14 offen offset:0
    s_add_u32 s8, s8, 1024
    s_add_u32 s9, s9, 1024
    s_waitcnt vmcnt(9)
    v_mfma_f32_32x32x16_bf16 v[64:79], v[32:35], v[36:39], v[64:79]
    v_mfma_f32_32x32x16_bf16 v[80:95], v[32:35], v[40:43], v[80:95]
    buffer_load_dwordx4 v[32:35], v3, s[24:27], s8 offen offset:0
    buffer_load_dwordx4 v[36:39], v3, s[24:27], s9 offen offset:0
    s_add_u32 s14, s9, 88064
    buffer_load_dwordx4 v[40:43], v3, s[24:27], s14 offen offset:0
    s_add_u32 s8, s8, 1024
    s_add_u32 s9, s9, 1024
    s_waitcnt vmcnt(9)
    v_mfma_f32_32x32x16_bf16 v[64:79], v[44:47], v[48:51], v[64:79]
    v_mfma_f32_32x32x16_bf16 v[80:95], v[44:47], v[52:55], v[80:95]
    buffer_load_dwordx4 v[44:47], v3, s[24:27], s8 offen offset:0
    buffer_load_dwordx4 v[48:51], v3, s[24:27], s9 offen offset:0
    s_add_u32 s14, s9, 88064
    buffer_load_dwordx4 v[52:55], v3, s[24:27], s14 offen offset:0
    s_add_u32 s8, s8, 1024
    s_add_u32 s9, s9, 1024
    s_waitcnt vmcnt(9)
    v_mfma_f32_32x32x16_bf16 v[64:79], v[8:11], v[12:15], v[64:79]
    v_mfma_f32_32x32x16_bf16 v[80:95], v[8:11], v[16:19], v[80:95]
    buffer_load_dwordx4 v[8:11], v3, s[24:27], s8 offen offset:0
    buffer_load_dwordx4 v[12:15], v3, s[24:27], s9 offen offset:0
    s_add_u32 s14, s9, 88064
    buffer_load_dwordx4 v[16:19], v3, s[24:27], s14 offen offset:0
    s_add_u32 s8, s8, 1024
    s_add_u32 s9, s9, 1024
    s_waitcnt vmcnt(9)
    v_mfma_f32_32x32x16_bf16 v[64:79], v[20:23], v[24:27], v[64:79]
    v_mfma_f32_32x32x16_bf16 v[80:95], v[20:23], v[28:31], v[80:95]
    buffer_load_dwordx4 v[20:23], v3, s[24:27], s8 offen offset:0
    buffer_load_dwordx4 v[24:27], v3, s[24:27], s9 offen offset:0
    s_add_u32 s14, s9, 88064
    buffer_load_dwordx4 v[28:31], v3, s[24:27], s14 offen offset:0
    s_add_u32 s8, s8, 1024
    s_add_u32 s9, s9, 1024
    s_waitcnt vmcnt(9)
    v_mfma_f32_32x32x16_bf16 v[64:79], v[32:35], v[36:39], v[64:79]
    v_mfma_f32_32x32x16_bf16 v[80:95], v[32:35], v[40:43], v[80:95]
    buffer_load_dwordx4 v[32:35], v3, s[24:27], s8 offen offset:0
    buffer_load_dwordx4 v[36:39], v3, s[24:27], s9 offen offset:0
    s_add_u32 s14, s9, 88064
    buffer_load_dwordx4 v[40:43], v3, s[24:27], s14 offen offset:0
    s_add_u32 s8, s8, 1024
    s_add_u32 s9, s9, 1024
    s_waitcnt vmcnt(9)
    v_mfma_f32_32x32x16_bf16 v[64:79], v[44:47], v[48:51], v[64:79]
    v_mfma_f32_32x32x16_bf16 v[80:95], v[44:47], v[52:55], v[80:95]
    buffer_load_dwordx4 v[44:47], v3, s[24:27], s8 offen offset:0
    buffer_load_dwordx4 v[48:51], v3, s[24:27], s9 offen offset:0
    s_add_u32 s14, s9, 88064
    buffer_load_dwordx4 v[52:55], v3, s[24:27], s14 offen offset:0
    s_add_u32 s8, s8, 1024
    s_add_u32 s9, s9, 1024
    s_waitcnt vmcnt(9)
    v_mfma_f32_32x32x16_bf16 v[64:79], v[8:11], v[12:15], v[64:79]
    v_mfma_f32_32x32x16_bf16 v[80:95], v[8:11], v[16:19], v[80:95]
    buffer_load_dwordx4 v[8:11], v3, s[24:27], s8 offen offset:0
    buffer_load_dwordx4 v[12:15], v3, s[24:27], s9 offen offset:0
    s_add_u32 s14, s9, 88064
    buffer_load_dwordx4 v[16:19], v3, s[24:27], s14 offen offset:0
    s_add_u32 s8, s8, 1024
    s_add_u32 s9, s9, 1024
    s_waitcnt vmcnt(9)
    v_mfma_f32_32x32x16_bf16 v[64:79], v[20:23], v[24:27], v[64:79]
    v_mfma_f32_32x32x16_bf16 v[80:95], v[20:23], v[28:31], v[80:95]
    buffer_load_dwordx4 v[20:23], v3, s[24:27], s8 offen offset:0
    buffer_load_dwordx4 v[24:27], v3, s[24:27], s9 offen offset:0
    s_add_u32 s14, s9, 88064
    buffer_load_dwordx4 v[28:31], v3, s[24:27], s14 offen offset:0
    s_add_u32 s8, s8, 1024
    s_add_u32 s9, s9, 1024
    s_waitcnt vmcnt(9)
    v_mfma_f32_32x32x16_bf16 v[64:79], v[32:35], v[36:39], v[64:79]
    v_mfma_f32_32x32x16_bf16 v[80:95], v[32:35], v[40:43], v[80:95]
    buffer_load_dwordx4 v[32:35], v3, s[24:27], s8 offen offset:0
    buffer_load_dwordx4 v[36:39], v3, s[24:27], s9 offen offset:0
    s_add_u32 s14, s9, 88064
    buffer_load_dwordx4 v[40:43], v3, s[24:27], s14 offen offset:0
    s_add_u32 s8, s8, 1024
    s_add_u32 s9, s9, 1024
    s_waitcnt vmcnt(9)
    v_mfma_f32_32x32x16_bf16 v[64:79], v[44:47], v[48:51], v[64:79]
    v_mfma_f32_32x32x16_bf16 v[80:95], v[44:47], v[52:55], v[80:95]
    buffer_load_dwordx4 v[44:47], v3, s[24:27], s8 offen offset:0
    buffer_load_dwordx4 v[48:51], v3, s[24:27], s9 offen offset:0
    s_add_u32 s14, s9, 88064
    buffer_load_dwordx4 v[52:55], v3, s[24:27], s14 offen offset:0
    s_add_u32 s8, s8, 1024
    s_add_u32 s9, s9, 1024
    s_waitcnt vmcnt(9)
    v_mfma_f32_32x32x16_bf16 v[64:79], v[8:11], v[12:15], v[64:79]
    v_mfma_f32_32x32x16_bf16 v[80:95], v[8:11], v[16:19], v[80:95]
    buffer_load_dwordx4 v[8:11], v3, s[24:27], s8 offen offset:0
    buffer_load_dwordx4 v[12:15], v3, s[24:27], s9 offen offset:0
    s_add_u32 s14, s9, 88064
    buffer_load_dwordx4 v[16:19], v3, s[24:27], s14 offen offset:0
    s_add_u32 s8, s8, 1024
    s_add_u32 s9, s9, 1024
    s_waitcnt vmcnt(9)
    v_mfma_f32_32x32x16_bf16 v[64:79], v[20:23], v[24:27], v[64:79]
    v_mfma_f32_32x32x16_bf16 v[80:95], v[20:23], v[28:31], v[80:95]
    buffer_load_dwordx4 v[20:23], v3, s[24:27], s8 offen offset:0
    buffer_load_dwordx4 v[24:27], v3, s[24:27], s9 offen offset:0
    s_add_u32 s14, s9, 88064
    buffer_load_dwordx4 v[28:31], v3, s[24:27], s14 offen offset:0
    s_add_u32 s8, s8, 1024
    s_add_u32 s9, s9, 1024
    s_waitcnt vmcnt(9)
    v_mfma_f32_32x32x16_bf16 v[64:79], v[32:35], v[36:39], v[64:79]
    v_mfma_f32_32x32x16_bf16 v[80:95], v[32:35], v[40:43], v[80:95]
    buffer_load_dwordx4 v[32:35], v3, s[24:27], s8 offen offset:0
    buffer_load_dwordx4 v[36:39], v3, s[24:27], s9 offen offset:0
    s_add_u32 s14, s9, 88064
    buffer_load_dwordx4 v[40:43], v3, s[24:27], s14 offen offset:0
    s_add_u32 s8, s8, 1024
    s_add_u32 s9, s9, 1024
    s_waitcnt vmcnt(9)
    v_mfma_f32_32x32x16_bf16 v[64:79], v[44:47], v[48:51], v[64:79]
    v_mfma_f32_32x32x16_bf16 v[80:95], v[44:47], v[52:55], v[80:95]
    buffer_load_dwordx4 v[44:47], v3, s[24:27], s8 offen offset:0
    buffer_load_dwordx4 v[48:51], v3, s[24:27], s9 offen offset:0
    s_add_u32 s14, s9, 88064
    buffer_load_dwordx4 v[52:55], v3, s[24:27], s14 offen offset:0
    s_add_u32 s8, s8, 1024
    s_add_u32 s9, s9, 1024
    s_waitcnt vmcnt(9)
    v_mfma_f32_32x32x16_bf16 v[64:79], v[8:11], v[12:15], v[64:79]
    v_mfma_f32_32x32x16_bf16 v[80:95], v[8:11], v[16:19], v[80:95]
    buffer_load_dwordx4 v[8:11], v3, s[24:27], s8 offen offset:0
    buffer_load_dwordx4 v[12:15], v3, s[24:27], s9 offen offset:0
    s_add_u32 s14, s9, 88064
    buffer_load_dwordx4 v[16:19], v3, s[24:27], s14 offen offset:0
    s_add_u32 s8, s8, 1024
    s_add_u32 s9, s9, 1024
    s_waitcnt vmcnt(9)
    v_mfma_f32_32x32x16_bf16 v[64:79], v[20:23], v[24:27], v[64:79]
    v_mfma_f32_32x32x16_bf16 v[80:95], v[20:23], v[28:31], v[80:95]
    buffer_load_dwordx4 v[20:23], v3, s[24:27], s8 offen offset:0
    buffer_load_dwordx4 v[24:27], v3, s[24:27], s9 offen offset:0
    s_add_u32 s14, s9, 88064
    buffer_load_dwordx4 v[28:31], v3, s[24:27], s14 offen offset:0
    s_add_u32 s8, s8, 1024
    s_add_u32 s9, s9, 1024
    s_waitcnt vmcnt(9)
    v_mfma_f32_32x32x16_bf16 v[64:79], v[32:35], v[36:39], v[64:79]
    v_mfma_f32_32x32x16_bf16 v[80:95], v[32:35], v[40:43], v[80:95]
    buffer_load_dwordx4 v[32:35], v3, s[24:27], s8 offen offset:0
    buffer_load_dwordx4 v[36:39], v3, s[24:27], s9 offen offset:0
    s_add_u32 s14, s9, 88064
    buffer_load_dwordx4 v[40:43], v3, s[24:27], s14 offen offset:0
    s_add_u32 s8, s8, 1024
    s_add_u32 s9, s9, 1024
    s_waitcnt vmcnt(9)
    v_mfma_f32_32x32x16_bf16 v[64:79], v[44:47], v[48:51], v[64:79]
    v_mfma_f32_32x32x16_bf16 v[80:95], v[44:47], v[52:55], v[80:95]
    buffer_load_dwordx4 v[44:47], v3, s[24:27], s8 offen offset:0
    buffer_load_dwordx4 v[48:51], v3, s[24:27], s9 offen offset:0
    s_add_u32 s14, s9, 88064
    buffer_load_dwordx4 v[52:55], v3, s[24:27], s14 offen offset:0
    s_add_u32 s8, s8, 1024
    s_add_u32 s9, s9, 1024
    s_waitcnt vmcnt(9)
    v_mfma_f32_32x32x16_bf16 v[64:79], v[8:11], v[12:15], v[64:79]
    v_mfma_f32_32x32x16_bf16 v[80:95], v[8:11], v[16:19], v[80:95]
    buffer_load_dwordx4 v[8:11], v3, s[24:27], s8 offen offset:0
    buffer_load_dwordx4 v[12:15], v3, s[24:27], s9 offen offset:0
    s_add_u32 s14, s9, 88064
    buffer_load_dwordx4 v[16:19], v3, s[24:27], s14 offen offset:0
    s_add_u32 s8, s8, 1024
    s_add_u32 s9, s9, 1024
    s_waitcnt vmcnt(9)
    v_mfma_f32_32x32x16_bf16 v[64:79], v[20:23], v[24:27], v[64:79]
    v_mfma_f32_32x32x16_bf16 v[80:95], v[20:23], v[28:31], v[80:95]
    buffer_load_dwordx4 v[20:23], v3, s[24:27], s8 offen offset:0
    buffer_load_dwordx4 v[24:27], v3, s[24:27], s9 offen offset:0
    s_add_u32 s14, s9, 88064
    buffer_load_dwordx4 v[28:31], v3, s[24:27], s14 offen offset:0
    s_add_u32 s8, s8, 1024
    s_add_u32 s9, s9, 1024
    s_waitcnt vmcnt(9)
    v_mfma_f32_32x32x16_bf16 v[64:79], v[32:35], v[36:39], v[64:79]
    v_mfma_f32_32x32x16_bf16 v[80:95], v[32:35], v[40:43], v[80:95]
    buffer_load_dwordx4 v[32:35], v3, s[24:27], s8 offen offset:0
    buffer_load_dwordx4 v[36:39], v3, s[24:27], s9 offen offset:0
    s_add_u32 s14, s9, 88064
    buffer_load_dwordx4 v[40:43], v3, s[24:27], s14 offen offset:0
    s_add_u32 s8, s8, 1024
    s_add_u32 s9, s9, 1024
    s_waitcnt vmcnt(9)
    v_mfma_f32_32x32x16_bf16 v[64:79], v[44:47], v[48:51], v[64:79]
    v_mfma_f32_32x32x16_bf16 v[80:95], v[44:47], v[52:55], v[80:95]
    buffer_load_dwordx4 v[44:47], v3, s[24:27], s8 offen offset:0
    buffer_load_dwordx4 v[48:51], v3, s[24:27], s9 offen offset:0
    s_add_u32 s14, s9, 88064
    buffer_load_dwordx4 v[52:55], v3, s[24:27], s14 offen offset:0
    s_add_u32 s8, s8, 1024
    s_add_u32 s9, s9, 1024
    s_waitcnt vmcnt(9)
    v_mfma_f32_32x32x16_bf16 v[64:79], v[8:11], v[12:15], v[64:79]
    v_mfma_f32_32x32x16_bf16 v[80:95], v[8:11], v[16:19], v[80:95]
    buffer_load_dwordx4 v[8:11], v3, s[24:27], s8 offen offset:0
    buffer_load_dwordx4 v[12:15], v3, s[24:27], s9 offen offset:0
    s_add_u32 s14, s9, 88064
    buffer_load_dwordx4 v[16:19], v3, s[24:27], s14 offen offset:0
    s_add_u32 s8, s8, 1024
    s_add_u32 s9, s9, 1024
    s_waitcnt vmcnt(9)
    v_mfma_f32_32x32x16_bf16 v[64:79], v[20:23], v[24:27], v[64:79]
    v_mfma_f32_32x32x16_bf16 v[80:95], v[20:23], v[28:31], v[80:95]
    buffer_load_dwordx4 v[20:23], v3, s[24:27], s8 offen offset:0
    buffer_load_dwordx4 v[24:27], v3, s[24:27], s9 offen offset:0
    s_add_u32 s14, s9, 88064
    buffer_load_dwordx4 v[28:31], v3, s[24:27], s14 offen offset:0
    s_add_u32 s8, s8, 1024
    s_add_u32 s9, s9, 1024
    s_waitcnt vmcnt(9)
    v_mfma_f32_32x32x16_bf16 v[64:79], v[32:35], v[36:39], v[64:79]
    v_mfma_f32_32x32x16_bf16 v[80:95], v[32:35], v[40:43], v[80:95]
    buffer_load_dwordx4 v[32:35], v3, s[24:27], s8 offen offset:0
    buffer_load_dwordx4 v[36:39], v3, s[24:27], s9 offen offset:0
    s_add_u32 s14, s9, 88064
    buffer_load_dwordx4 v[40:43], v3, s[24:27], s14 offen offset:0
    s_add_u32 s8, s8, 1024
    s_add_u32 s9, s9, 1024
    s_waitcnt vmcnt(9)
    v_mfma_f32_32x32x16_bf16 v[64:79], v[44:47], v[48:51], v[64:79]
    v_mfma_f32_32x32x16_bf16 v[80:95], v[44:47], v[52:55], v[80:95]
    buffer_load_dwordx4 v[44:47], v3, s[24:27], s8 offen offset:0
    buffer_load_dwordx4 v[48:51], v3, s[24:27], s9 offen offset:0
    s_add_u32 s14, s9, 88064
    buffer_load_dwordx4 v[52:55], v3, s[24:27], s14 offen offset:0
    s_add_u32 s8, s8, 1024
    s_add_u32 s9, s9, 1024
    s_waitcnt vmcnt(9)
    v_mfma_f32_32x32x16_bf16 v[64:79], v[8:11], v[12:15], v[64:79]
    v_mfma_f32_32x32x16_bf16 v[80:95], v[8:11], v[16:19], v[80:95]
    buffer_load_dwordx4 v[8:11], v3, s[24:27], s8 offen offset:0
    buffer_load_dwordx4 v[12:15], v3, s[24:27], s9 offen offset:0
    s_add_u32 s14, s9, 88064
    buffer_load_dwordx4 v[16:19], v3, s[24:27], s14 offen offset:0
    s_add_u32 s8, s8, 1024
    s_add_u32 s9, s9, 1024
    s_waitcnt vmcnt(9)
    v_mfma_f32_32x32x16_bf16 v[64:79], v[20:23], v[24:27], v[64:79]
    v_mfma_f32_32x32x16_bf16 v[80:95], v[20:23], v[28:31], v[80:95]
    buffer_load_dwordx4 v[20:23], v3, s[24:27], s8 offen offset:0
    buffer_load_dwordx4 v[24:27], v3, s[24:27], s9 offen offset:0
    s_add_u32 s14, s9, 88064
    buffer_load_dwordx4 v[28:31], v3, s[24:27], s14 offen offset:0
    s_add_u32 s8, s8, 1024
    s_add_u32 s9, s9, 1024
    s_waitcnt vmcnt(9)
    v_mfma_f32_32x32x16_bf16 v[64:79], v[32:35], v[36:39], v[64:79]
    v_mfma_f32_32x32x16_bf16 v[80:95], v[32:35], v[40:43], v[80:95]
    buffer_load_dwordx4 v[32:35], v3, s[24:27], s8 offen offset:0
    buffer_load_dwordx4 v[36:39], v3, s[24:27], s9 offen offset:0
    s_add_u32 s14, s9, 88064
    buffer_load_dwordx4 v[40:43], v3, s[24:27], s14 offen offset:0
    s_add_u32 s8, s8, 1024
    s_add_u32 s9, s9, 1024
    s_waitcnt vmcnt(9)
    v_mfma_f32_32x32x16_bf16 v[64:79], v[44:47], v[48:51], v[64:79]
    v_mfma_f32_32x32x16_bf16 v[80:95], v[44:47], v[52:55], v[80:95]
    buffer_load_dwordx4 v[44:47], v3, s[24:27], s8 offen offset:0
    buffer_load_dwordx4 v[48:51], v3, s[24:27], s9 offen offset:0
    s_add_u32 s14, s9, 88064
    buffer_load_dwordx4 v[52:55], v3, s[24:27], s14 offen offset:0
    s_add_u32 s8, s8, 1024
    s_add_u32 s9, s9, 1024
    s_waitcnt vmcnt(9)
    v_mfma_f32_32x32x16_bf16 v[64:79], v[8:11], v[12:15], v[64:79]
    v_mfma_f32_32x32x16_bf16 v[80:95], v[8:11], v[16:19], v[80:95]
    buffer_load_dwordx4 v[8:11], v3, s[24:27], s8 offen offset:0
    buffer_load_dwordx4 v[12:15], v3, s[24:27], s9 offen offset:0
    s_add_u32 s14, s9, 88064
    buffer_load_dwordx4 v[16:19], v3, s[24:27], s14 offen offset:0
    s_add_u32 s8, s8, 1024
    s_add_u32 s9, s9, 1024
    s_waitcnt vmcnt(9)
    v_mfma_f32_32x32x16_bf16 v[64:79], v[20:23], v[24:27], v[64:79]
    v_mfma_f32_32x32x16_bf16 v[80:95], v[20:23], v[28:31], v[80:95]
    buffer_load_dwordx4 v[20:23], v3, s[24:27], s8 offen offset:0
    buffer_load_dwordx4 v[24:27], v3, s[24:27], s9 offen offset:0
    s_add_u32 s14, s9, 88064
    buffer_load_dwordx4 v[28:31], v3, s[24:27], s14 offen offset:0
    s_add_u32 s8, s8, 1024
    s_add_u32 s9, s9, 1024
    s_waitcnt vmcnt(9)
    v_mfma_f32_32x32x16_bf16 v[64:79], v[32:35], v[36:39], v[64:79]
    v_mfma_f32_32x32x16_bf16 v[80:95], v[32:35], v[40:43], v[80:95]
    buffer_load_dwordx4 v[32:35], v3, s[24:27], s8 offen offset:0
    buffer_load_dwordx4 v[36:39], v3, s[24:27], s9 offen offset:0
    s_add_u32 s14, s9, 88064
    buffer_load_dwordx4 v[40:43], v3, s[24:27], s14 offen offset:0
    s_add_u32 s8, s8, 1024
    s_add_u32 s9, s9, 1024
    s_waitcnt vmcnt(9)
    v_mfma_f32_32x32x16_bf16 v[64:79], v[44:47], v[48:51], v[64:79]
    v_mfma_f32_32x32x16_bf16 v[80:95], v[44:47], v[52:55], v[80:95]
    buffer_load_dwordx4 v[44:47], v3, s[24:27], s8 offen offset:0
    buffer_load_dwordx4 v[48:51], v3, s[24:27], s9 offen offset:0
    s_add_u32 s14, s9, 88064
    buffer_load_dwordx4 v[52:55], v3, s[24:27], s14 offen offset:0
    s_add_u32 s8, s8, 1024
    s_add_u32 s9, s9, 1024
    s_waitcnt vmcnt(9)
    v_mfma_f32_32x32x16_bf16 v[64:79], v[8:11], v[12:15], v[64:79]
    v_mfma_f32_32x32x16_bf16 v[80:95], v[8:11], v[16:19], v[80:95]
    buffer_load_dwordx4 v[8:11], v3, s[24:27], s8 offen offset:0
    buffer_load_dwordx4 v[12:15], v3, s[24:27], s9 offen offset:0
    s_add_u32 s14, s9, 88064
    buffer_load_dwordx4 v[16:19], v3, s[24:27], s14 offen offset:0
    s_add_u32 s8, s8, 1024
    s_add_u32 s9, s9, 1024
    s_waitcnt vmcnt(9)
    v_mfma_f32_32x32x16_bf16 v[64:79], v[20:23], v[24:27], v[64:79]
    v_mfma_f32_32x32x16_bf16 v[80:95], v[20:23], v[28:31], v[80:95]
    buffer_load_dwordx4 v[20:23], v3, s[24:27], s8 offen offset:0
    buffer_load_dwordx4 v[24:27], v3, s[24:27], s9 offen offset:0
    s_add_u32 s14, s9, 88064
    buffer_load_dwordx4 v[28:31], v3, s[24:27], s14 offen offset:0
    s_add_u32 s8, s8, 1024
    s_add_u32 s9, s9, 1024
    s_waitcnt vmcnt(9)
    v_mfma_f32_32x32x16_bf16 v[64:79], v[32:35], v[36:39], v[64:79]
    v_mfma_f32_32x32x16_bf16 v[80:95], v[32:35], v[40:43], v[80:95]
    buffer_load_dwordx4 v[32:35], v3, s[24:27], s8 offen offset:0
    buffer_load_dwordx4 v[36:39], v3, s[24:27], s9 offen offset:0
    s_add_u32 s14, s9, 88064
    buffer_load_dwordx4 v[40:43], v3, s[24:27], s14 offen offset:0
    s_add_u32 s8, s8, 1024
    s_add_u32 s9, s9, 1024
    s_waitcnt vmcnt(9)
    v_mfma_f32_32x32x16_bf16 v[64:79], v[44:47], v[48:51], v[64:79]
    v_mfma_f32_32x32x16_bf16 v[80:95], v[44:47], v[52:55], v[80:95]
    buffer_load_dwordx4 v[44:47], v3, s[24:27], s8 offen offset:0
    buffer_load_dwordx4 v[48:51], v3, s[24:27], s9 offen offset:0
    s_add_u32 s14, s9, 88064
    buffer_load_dwordx4 v[52:55], v3, s[24:27], s14 offen offset:0
    s_add_u32 s8, s8, 1024
    s_add_u32 s9, s9, 1024
    s_waitcnt vmcnt(9)
    v_mfma_f32_32x32x16_bf16 v[64:79], v[8:11], v[12:15], v[64:79]
    v_mfma_f32_32x32x16_bf16 v[80:95], v[8:11], v[16:19], v[80:95]
    buffer_load_dwordx4 v[8:11], v3, s[24:27], s8 offen offset:0
    buffer_load_dwordx4 v[12:15], v3, s[24:27], s9 offen offset:0
    s_add_u32 s14, s9, 88064
    buffer_load_dwordx4 v[16:19], v3, s[24:27], s14 offen offset:0
    s_add_u32 s8, s8, 1024
    s_add_u32 s9, s9, 1024
    s_waitcnt vmcnt(9)
    v_mfma_f32_32x32x16_bf16 v[64:79], v[20:23], v[24:27], v[64:79]
    v_mfma_f32_32x32x16_bf16 v[80:95], v[20:23], v[28:31], v[80:95]
    buffer_load_dwordx4 v[20:23], v3, s[24:27], s8 offen offset:0
    buffer_load_dwordx4 v[24:27], v3, s[24:27], s9 offen offset:0
    s_add_u32 s14, s9, 88064
    buffer_load_dwordx4 v[28:31], v3, s[24:27], s14 offen offset:0
    s_add_u32 s8, s8, 1024
    s_add_u32 s9, s9, 1024
    s_waitcnt vmcnt(9)
    v_mfma_f32_32x32x16_bf16 v[64:79], v[32:35], v[36:39], v[64:79]
    v_mfma_f32_32x32x16_bf16 v[80:95], v[32:35], v[40:43], v[80:95]
    buffer_load_dwordx4 v[32:35], v3, s[24:27], s8 offen offset:0
    buffer_load_dwordx4 v[36:39], v3, s[24:27], s9 offen offset:0
    s_add_u32 s14, s9, 88064
    buffer_load_dwordx4 v[40:43], v3, s[24:27], s14 offen offset:0
    s_add_u32 s8, s8, 1024
    s_add_u32 s9, s9, 1024
    s_waitcnt vmcnt(9)
    v_mfma_f32_32x32x16_bf16 v[64:79], v[44:47], v[48:51], v[64:79]
    v_mfma_f32_32x32x16_bf16 v[80:95], v[44:47], v[52:55], v[80:95]
    buffer_load_dwordx4 v[44:47], v3, s[24:27], s8 offen offset:0
    buffer_load_dwordx4 v[48:51], v3, s[24:27], s9 offen offset:0
    s_add_u32 s14, s9, 88064
    buffer_load_dwordx4 v[52:55], v3, s[24:27], s14 offen offset:0
    s_add_u32 s8, s8, 1024
    s_add_u32 s9, s9, 1024
    s_waitcnt vmcnt(9)
    v_mfma_f32_32x32x16_bf16 v[64:79], v[8:11], v[12:15], v[64:79]
    v_mfma_f32_32x32x16_bf16 v[80:95], v[8:11], v[16:19], v[80:95]
    buffer_load_dwordx4 v[8:11], v3, s[24:27], s8 offen offset:0
    buffer_load_dwordx4 v[12:15], v3, s[24:27], s9 offen offset:0
    s_add_u32 s14, s9, 88064
    buffer_load_dwordx4 v[16:19], v3, s[24:27], s14 offen offset:0
    s_add_u32 s8, s8, 1024
    s_add_u32 s9, s9, 1024
    s_waitcnt vmcnt(9)
    v_mfma_f32_32x32x16_bf16 v[64:79], v[20:23], v[24:27], v[64:79]
    v_mfma_f32_32x32x16_bf16 v[80:95], v[20:23], v[28:31], v[80:95]
    buffer_load_dwordx4 v[20:23], v3, s[24:27], s8 offen offset:0
    buffer_load_dwordx4 v[24:27], v3, s[24:27], s9 offen offset:0
    s_add_u32 s14, s9, 88064
    buffer_load_dwordx4 v[28:31], v3, s[24:27], s14 offen offset:0
    s_add_u32 s8, s8, 1024
    s_add_u32 s9, s9, 1024
    s_waitcnt vmcnt(9)
    v_mfma_f32_32x32x16_bf16 v[64:79], v[32:35], v[36:39], v[64:79]
    v_mfma_f32_32x32x16_bf16 v[80:95], v[32:35], v[40:43], v[80:95]
    buffer_load_dwordx4 v[32:35], v3, s[24:27], s8 offen offset:0
    buffer_load_dwordx4 v[36:39], v3, s[24:27], s9 offen offset:0
    s_add_u32 s14, s9, 88064
    buffer_load_dwordx4 v[40:43], v3, s[24:27], s14 offen offset:0
    s_add_u32 s8, s8, 1024
    s_add_u32 s9, s9, 1024
    s_waitcnt vmcnt(9)
    v_mfma_f32_32x32x16_bf16 v[64:79], v[44:47], v[48:51], v[64:79]
    v_mfma_f32_32x32x16_bf16 v[80:95], v[44:47], v[52:55], v[80:95]
    buffer_load_dwordx4 v[44:47], v3, s[24:27], s8 offen offset:0
    buffer_load_dwordx4 v[48:51], v3, s[24:27], s9 offen offset:0
    s_add_u32 s14, s9, 88064
    buffer_load_dwordx4 v[52:55], v3, s[24:27], s14 offen offset:0
    s_add_u32 s8, s8, 1024
    s_add_u32 s9, s9, 1024
    s_waitcnt vmcnt(9)
    v_mfma_f32_32x32x16_bf16 v[64:79], v[8:11], v[12:15], v[64:79]
    v_mfma_f32_32x32x16_bf16 v[80:95], v[8:11], v[16:19], v[80:95]
    buffer_load_dwordx4 v[8:11], v3, s[24:27], s8 offen offset:0
    buffer_load_dwordx4 v[12:15], v3, s[24:27], s9 offen offset:0
    s_add_u32 s14, s9, 88064
    buffer_load_dwordx4 v[16:19], v3, s[24:27], s14 offen offset:0
    s_add_u32 s8, s8, 1024
    s_add_u32 s9, s9, 1024
    s_waitcnt vmcnt(9)
    v_mfma_f32_32x32x16_bf16 v[64:79], v[20:23], v[24:27], v[64:79]
    v_mfma_f32_32x32x16_bf16 v[80:95], v[20:23], v[28:31], v[80:95]
    buffer_load_dwordx4 v[20:23], v3, s[24:27], s8 offen offset:0
    buffer_load_dwordx4 v[24:27], v3, s[24:27], s9 offen offset:0
    s_add_u32 s14, s9, 88064
    buffer_load_dwordx4 v[28:31], v3, s[24:27], s14 offen offset:0
    s_add_u32 s8, s8, 1024
    s_add_u32 s9, s9, 1024
    s_waitcnt vmcnt(9)
    v_mfma_f32_32x32x16_bf16 v[64:79], v[32:35], v[36:39], v[64:79]
    v_mfma_f32_32x32x16_bf16 v[80:95], v[32:35], v[40:43], v[80:95]
    s_waitcnt vmcnt(6)
    v_mfma_f32_32x32x16_bf16 v[64:79], v[44:47], v[48:51], v[64:79]
    v_mfma_f32_32x32x16_bf16 v[80:95], v[44:47], v[52:55], v[80:95]
    s_waitcnt vmcnt(3)
    v_mfma_f32_32x32x16_bf16 v[64:79], v[8:11], v[12:15], v[64:79]
    v_mfma_f32_32x32x16_bf16 v[80:95], v[8:11], v[16:19], v[80:95]
    s_waitcnt vmcnt(0)
    v_mfma_f32_32x32x16_bf16 v[64:79], v[20:23], v[24:27], v[64:79]
    v_mfma_f32_32x32x16_bf16 v[80:95], v[20:23], v[28:31], v[80:95]
    v_and_b32 v6, 31, v1
    v_lshrrev_b32 v7, 5, v1
    v_lshlrev_b32 v7, 12, v7
    v_lshl_add_u32 v7, v6, 1, v7
    s_lshl_b32 s16, s16, 15
    s_lshl_b32 s17, s5, 7
    s_add_u32 s16, s16, s17
    v_add_u32 v7, s16, v7
    s_mov_b32 s18, 6422528
    buffer_load_ushort v8, v7, s[24:27], s18 offen offset:0
    buffer_load_ushort v9, v7, s[24:27], s18 offen offset:1024
    buffer_load_ushort v10, v7, s[24:27], s18 offen offset:2048
    buffer_load_ushort v11, v7, s[24:27], s18 offen offset:3072
    s_add_u32 s99, s18, 8192
    buffer_load_ushort v12, v7, s[24:27], s99 offen offset:0
    s_add_u32 s99, s18, 8192
    buffer_load_ushort v13, v7, s[24:27], s99 offen offset:1024
    s_add_u32 s99, s18, 8192
    buffer_load_ushort v14, v7, s[24:27], s99 offen offset:2048
    s_add_u32 s99, s18, 8192
    buffer_load_ushort v15, v7, s[24:27], s99 offen offset:3072
    s_add_u32 s99, s18, 16384
    buffer_load_ushort v16, v7, s[24:27], s99 offen offset:0
    s_add_u32 s99, s18, 16384
    buffer_load_ushort v17, v7, s[24:27], s99 offen offset:1024
    s_add_u32 s99, s18, 16384
    buffer_load_ushort v18, v7, s[24:27], s99 offen offset:2048
    s_add_u32 s99, s18, 16384
    buffer_load_ushort v19, v7, s[24:27], s99 offen offset:3072
    s_add_u32 s99, s18, 24576
    buffer_load_ushort v20, v7, s[24:27], s99 offen offset:0
    s_add_u32 s99, s18, 24576
    buffer_load_ushort v21, v7, s[24:27], s99 offen offset:1024
    s_add_u32 s99, s18, 24576
    buffer_load_ushort v22, v7, s[24:27], s99 offen offset:2048
    s_add_u32 s99, s18, 24576
    buffer_load_ushort v23, v7, s[24:27], s99 offen offset:3072
    buffer_load_ushort v24, v7, s[24:27], s18 offen offset:64
    buffer_load_ushort v25, v7, s[24:27], s18 offen offset:1088
    buffer_load_ushort v26, v7, s[24:27], s18 offen offset:2112
    buffer_load_ushort v27, v7, s[24:27], s18 offen offset:3136
    s_add_u32 s99, s18, 8192
    buffer_load_ushort v28, v7, s[24:27], s99 offen offset:64
    s_add_u32 s99, s18, 8192
    buffer_load_ushort v29, v7, s[24:27], s99 offen offset:1088
    s_add_u32 s99, s18, 8192
    buffer_load_ushort v30, v7, s[24:27], s99 offen offset:2112
    s_add_u32 s99, s18, 8192
    buffer_load_ushort v31, v7, s[24:27], s99 offen offset:3136
    s_add_u32 s99, s18, 16384
    buffer_load_ushort v32, v7, s[24:27], s99 offen offset:64
    s_add_u32 s99, s18, 16384
    buffer_load_ushort v33, v7, s[24:27], s99 offen offset:1088
    s_add_u32 s99, s18, 16384
    buffer_load_ushort v34, v7, s[24:27], s99 offen offset:2112
    s_add_u32 s99, s18, 16384
    buffer_load_ushort v35, v7, s[24:27], s99 offen offset:3136
    s_add_u32 s99, s18, 24576
    buffer_load_ushort v36, v7, s[24:27], s99 offen offset:64
    s_add_u32 s99, s18, 24576
    buffer_load_ushort v37, v7, s[24:27], s99 offen offset:1088
    s_add_u32 s99, s18, 24576
    buffer_load_ushort v38, v7, s[24:27], s99 offen offset:2112
    s_add_u32 s99, s18, 24576
    buffer_load_ushort v39, v7, s[24:27], s99 offen offset:3136
    s_waitcnt vmcnt(0)
    s_nop 7
    v_cvt_pk_bf16_f32 v64, v64, v64
    v_lshlrev_b32 v64, 16, v64
    v_lshlrev_b32 v8, 16, v8
    v_add_f32 v64, v64, v8
    v_cvt_pk_bf16_f32 v64, v64, v64
    buffer_store_short v64, v7, s[28:31], 0 offen offset:0
    v_cvt_pk_bf16_f32 v65, v65, v65
    v_lshlrev_b32 v65, 16, v65
    v_lshlrev_b32 v9, 16, v9
    v_add_f32 v65, v65, v9
    v_cvt_pk_bf16_f32 v65, v65, v65
    buffer_store_short v65, v7, s[28:31], 0 offen offset:1024
    v_cvt_pk_bf16_f32 v66, v66, v66
    v_lshlrev_b32 v66, 16, v66
    v_lshlrev_b32 v10, 16, v10
    v_add_f32 v66, v66, v10
    v_cvt_pk_bf16_f32 v66, v66, v66
    buffer_store_short v66, v7, s[28:31], 0 offen offset:2048
    v_cvt_pk_bf16_f32 v67, v67, v67
    v_lshlrev_b32 v67, 16, v67
    v_lshlrev_b32 v11, 16, v11
    v_add_f32 v67, v67, v11
    v_cvt_pk_bf16_f32 v67, v67, v67
    buffer_store_short v67, v7, s[28:31], 0 offen offset:3072
    v_cvt_pk_bf16_f32 v68, v68, v68
    v_lshlrev_b32 v68, 16, v68
    v_lshlrev_b32 v12, 16, v12
    v_add_f32 v68, v68, v12
    v_cvt_pk_bf16_f32 v68, v68, v68
    s_add_u32 s99, 0, 8192
    buffer_store_short v68, v7, s[28:31], s99 offen offset:0
    v_cvt_pk_bf16_f32 v69, v69, v69
    v_lshlrev_b32 v69, 16, v69
    v_lshlrev_b32 v13, 16, v13
    v_add_f32 v69, v69, v13
    v_cvt_pk_bf16_f32 v69, v69, v69
    s_add_u32 s99, 0, 8192
    buffer_store_short v69, v7, s[28:31], s99 offen offset:1024
    v_cvt_pk_bf16_f32 v70, v70, v70
    v_lshlrev_b32 v70, 16, v70
    v_lshlrev_b32 v14, 16, v14
    v_add_f32 v70, v70, v14
    v_cvt_pk_bf16_f32 v70, v70, v70
    s_add_u32 s99, 0, 8192
    buffer_store_short v70, v7, s[28:31], s99 offen offset:2048
    v_cvt_pk_bf16_f32 v71, v71, v71
    v_lshlrev_b32 v71, 16, v71
    v_lshlrev_b32 v15, 16, v15
    v_add_f32 v71, v71, v15
    v_cvt_pk_bf16_f32 v71, v71, v71
    s_add_u32 s99, 0, 8192
    buffer_store_short v71, v7, s[28:31], s99 offen offset:3072
    v_cvt_pk_bf16_f32 v72, v72, v72
    v_lshlrev_b32 v72, 16, v72
    v_lshlrev_b32 v16, 16, v16
    v_add_f32 v72, v72, v16
    v_cvt_pk_bf16_f32 v72, v72, v72
    s_add_u32 s99, 0, 16384
    buffer_store_short v72, v7, s[28:31], s99 offen offset:0
    v_cvt_pk_bf16_f32 v73, v73, v73
    v_lshlrev_b32 v73, 16, v73
    v_lshlrev_b32 v17, 16, v17
    v_add_f32 v73, v73, v17
    v_cvt_pk_bf16_f32 v73, v73, v73
    s_add_u32 s99, 0, 16384
    buffer_store_short v73, v7, s[28:31], s99 offen offset:1024
    v_cvt_pk_bf16_f32 v74, v74, v74
    v_lshlrev_b32 v74, 16, v74
    v_lshlrev_b32 v18, 16, v18
    v_add_f32 v74, v74, v18
    v_cvt_pk_bf16_f32 v74, v74, v74
    s_add_u32 s99, 0, 16384
    buffer_store_short v74, v7, s[28:31], s99 offen offset:2048
    v_cvt_pk_bf16_f32 v75, v75, v75
    v_lshlrev_b32 v75, 16, v75
    v_lshlrev_b32 v19, 16, v19
    v_add_f32 v75, v75, v19
    v_cvt_pk_bf16_f32 v75, v75, v75
    s_add_u32 s99, 0, 16384
    buffer_store_short v75, v7, s[28:31], s99 offen offset:3072
    v_cvt_pk_bf16_f32 v76, v76, v76
    v_lshlrev_b32 v76, 16, v76
    v_lshlrev_b32 v20, 16, v20
    v_add_f32 v76, v76, v20
    v_cvt_pk_bf16_f32 v76, v76, v76
    s_add_u32 s99, 0, 24576
    buffer_store_short v76, v7, s[28:31], s99 offen offset:0
    v_cvt_pk_bf16_f32 v77, v77, v77
    v_lshlrev_b32 v77, 16, v77
    v_lshlrev_b32 v21, 16, v21
    v_add_f32 v77, v77, v21
    v_cvt_pk_bf16_f32 v77, v77, v77
    s_add_u32 s99, 0, 24576
    buffer_store_short v77, v7, s[28:31], s99 offen offset:1024
    v_cvt_pk_bf16_f32 v78, v78, v78
    v_lshlrev_b32 v78, 16, v78
    v_lshlrev_b32 v22, 16, v22
    v_add_f32 v78, v78, v22
    v_cvt_pk_bf16_f32 v78, v78, v78
    s_add_u32 s99, 0, 24576
    buffer_store_short v78, v7, s[28:31], s99 offen offset:2048
    v_cvt_pk_bf16_f32 v79, v79, v79
    v_lshlrev_b32 v79, 16, v79
    v_lshlrev_b32 v23, 16, v23
    v_add_f32 v79, v79, v23
    v_cvt_pk_bf16_f32 v79, v79, v79
    s_add_u32 s99, 0, 24576
    buffer_store_short v79, v7, s[28:31], s99 offen offset:3072
    v_cvt_pk_bf16_f32 v80, v80, v80
    v_lshlrev_b32 v80, 16, v80
    v_lshlrev_b32 v24, 16, v24
    v_add_f32 v80, v80, v24
    v_cvt_pk_bf16_f32 v80, v80, v80
    buffer_store_short v80, v7, s[28:31], 0 offen offset:64
    v_cvt_pk_bf16_f32 v81, v81, v81
    v_lshlrev_b32 v81, 16, v81
    v_lshlrev_b32 v25, 16, v25
    v_add_f32 v81, v81, v25
    v_cvt_pk_bf16_f32 v81, v81, v81
    buffer_store_short v81, v7, s[28:31], 0 offen offset:1088
    v_cvt_pk_bf16_f32 v82, v82, v82
    v_lshlrev_b32 v82, 16, v82
    v_lshlrev_b32 v26, 16, v26
    v_add_f32 v82, v82, v26
    v_cvt_pk_bf16_f32 v82, v82, v82
    buffer_store_short v82, v7, s[28:31], 0 offen offset:2112
    v_cvt_pk_bf16_f32 v83, v83, v83
    v_lshlrev_b32 v83, 16, v83
    v_lshlrev_b32 v27, 16, v27
    v_add_f32 v83, v83, v27
    v_cvt_pk_bf16_f32 v83, v83, v83
    buffer_store_short v83, v7, s[28:31], 0 offen offset:3136
    v_cvt_pk_bf16_f32 v84, v84, v84
    v_lshlrev_b32 v84, 16, v84
    v_lshlrev_b32 v28, 16, v28
    v_add_f32 v84, v84, v28
    v_cvt_pk_bf16_f32 v84, v84, v84
    s_add_u32 s99, 0, 8192
    buffer_store_short v84, v7, s[28:31], s99 offen offset:64
    v_cvt_pk_bf16_f32 v85, v85, v85
    v_lshlrev_b32 v85, 16, v85
    v_lshlrev_b32 v29, 16, v29
    v_add_f32 v85, v85, v29
    v_cvt_pk_bf16_f32 v85, v85, v85
    s_add_u32 s99, 0, 8192
    buffer_store_short v85, v7, s[28:31], s99 offen offset:1088
    v_cvt_pk_bf16_f32 v86, v86, v86
    v_lshlrev_b32 v86, 16, v86
    v_lshlrev_b32 v30, 16, v30
    v_add_f32 v86, v86, v30
    v_cvt_pk_bf16_f32 v86, v86, v86
    s_add_u32 s99, 0, 8192
    buffer_store_short v86, v7, s[28:31], s99 offen offset:2112
    v_cvt_pk_bf16_f32 v87, v87, v87
    v_lshlrev_b32 v87, 16, v87
    v_lshlrev_b32 v31, 16, v31
    v_add_f32 v87, v87, v31
    v_cvt_pk_bf16_f32 v87, v87, v87
    s_add_u32 s99, 0, 8192
    buffer_store_short v87, v7, s[28:31], s99 offen offset:3136
    v_cvt_pk_bf16_f32 v88, v88, v88
    v_lshlrev_b32 v88, 16, v88
    v_lshlrev_b32 v32, 16, v32
    v_add_f32 v88, v88, v32
    v_cvt_pk_bf16_f32 v88, v88, v88
    s_add_u32 s99, 0, 16384
    buffer_store_short v88, v7, s[28:31], s99 offen offset:64
    v_cvt_pk_bf16_f32 v89, v89, v89
    v_lshlrev_b32 v89, 16, v89
    v_lshlrev_b32 v33, 16, v33
    v_add_f32 v89, v89, v33
    v_cvt_pk_bf16_f32 v89, v89, v89
    s_add_u32 s99, 0, 16384
    buffer_store_short v89, v7, s[28:31], s99 offen offset:1088
    v_cvt_pk_bf16_f32 v90, v90, v90
    v_lshlrev_b32 v90, 16, v90
    v_lshlrev_b32 v34, 16, v34
    v_add_f32 v90, v90, v34
    v_cvt_pk_bf16_f32 v90, v90, v90
    s_add_u32 s99, 0, 16384
    buffer_store_short v90, v7, s[28:31], s99 offen offset:2112
    v_cvt_pk_bf16_f32 v91, v91, v91
    v_lshlrev_b32 v91, 16, v91
    v_lshlrev_b32 v35, 16, v35
    v_add_f32 v91, v91, v35
    v_cvt_pk_bf16_f32 v91, v91, v91
    s_add_u32 s99, 0, 16384
    buffer_store_short v91, v7, s[28:31], s99 offen offset:3136
    v_cvt_pk_bf16_f32 v92, v92, v92
    v_lshlrev_b32 v92, 16, v92
    v_lshlrev_b32 v36, 16, v36
    v_add_f32 v92, v92, v36
    v_cvt_pk_bf16_f32 v92, v92, v92
    s_add_u32 s99, 0, 24576
    buffer_store_short v92, v7, s[28:31], s99 offen offset:64
    v_cvt_pk_bf16_f32 v93, v93, v93
    v_lshlrev_b32 v93, 16, v93
    v_lshlrev_b32 v37, 16, v37
    v_add_f32 v93, v93, v37
    v_cvt_pk_bf16_f32 v93, v93, v93
    s_add_u32 s99, 0, 24576
    buffer_store_short v93, v7, s[28:31], s99 offen offset:1088
    v_cvt_pk_bf16_f32 v94, v94, v94
    v_lshlrev_b32 v94, 16, v94
    v_lshlrev_b32 v38, 16, v38
    v_add_f32 v94, v94, v38
    v_cvt_pk_bf16_f32 v94, v94, v94
    s_add_u32 s99, 0, 24576
    buffer_store_short v94, v7, s[28:31], s99 offen offset:2112
    v_cvt_pk_bf16_f32 v95, v95, v95
    v_lshlrev_b32 v95, 16, v95
    v_lshlrev_b32 v39, 16, v39
    v_add_f32 v95, v95, v39
    v_cvt_pk_bf16_f32 v95, v95, v95
    s_add_u32 s99, 0, 24576
    buffer_store_short v95, v7, s[28:31], s99 offen offset:3136
k5_kernel_end:
    s_endpgm
.section .rodata,"a"
.p2align 6
.amdhsa_kernel k1_kernel
  .amdhsa_next_free_vgpr 128
  .amdhsa_next_free_sgpr 102
  .amdhsa_accum_offset 128
  .amdhsa_group_segment_fixed_size 0
  .amdhsa_kernarg_size 80
  .amdhsa_user_sgpr_count 2
  .amdhsa_user_sgpr_kernarg_segment_ptr 1
  .amdhsa_system_sgpr_workgroup_id_x 1
.end_amdhsa_kernel
.p2align 6
.amdhsa_kernel k2_kernel
  .amdhsa_next_free_vgpr 160
  .amdhsa_next_free_sgpr 102
  .amdhsa_accum_offset 160
  .amdhsa_group_segment_fixed_size 0
  .amdhsa_kernarg_size 80
  .amdhsa_user_sgpr_count 2
  .amdhsa_user_sgpr_kernarg_segment_ptr 1
  .amdhsa_system_sgpr_workgroup_id_x 1
.end_amdhsa_kernel
.p2align 6
.amdhsa_kernel k3_kernel
  .amdhsa_next_free_vgpr 128
  .amdhsa_next_free_sgpr 102
  .amdhsa_accum_offset 128
  .amdhsa_group_segment_fixed_size 0
  .amdhsa_kernarg_size 80
  .amdhsa_user_sgpr_count 2
  .amdhsa_user_sgpr_kernarg_segment_ptr 1
  .amdhsa_system_sgpr_workgroup_id_x 1
.end_amdhsa_kernel
.p2align 6
.amdhsa_kernel k4_kernel
  .amdhsa_next_free_vgpr 160
  .amdhsa_next_free_sgpr 102
  .amdhsa_accum_offset 160
  .amdhsa_group_segment_fixed_size 0
  .amdhsa_kernarg_size 80
  .amdhsa_user_sgpr_count 2
  .amdhsa_user_sgpr_kernarg_segment_ptr 1
  .amdhsa_system_sgpr_workgroup_id_x 1
.end_amdhsa_kernel
.p2align 6
.amdhsa_kernel k5_kernel
  .amdhsa_next_free_vgpr 96
  .amdhsa_next_free_sgpr 102
  .amdhsa_accum_offset 96
  .amdhsa_group_segment_fixed_size 0
  .amdhsa_kernarg_size 80
  .amdhsa_user_sgpr_count 2
  .amdhsa_user_sgpr_kernarg_segment_ptr 1
  .amdhsa_system_sgpr_workgroup_id_x 1
.end_amdhsa_kernel
```
